```python
import torch

def _softmax(x, axis=-1):
    return torch.softmax(x, dim=axis)

def _gelu(x):
    return torch.nn.functional.gelu(x, approximate='tanh')

def _silu(x):
    return torch.nn.functional.silu(x)

def _sigmoid(x):
    return torch.sigmoid(x)

def _layernorm(x, axis=-1, eps=1e-05):
    m = x.mean(dim=axis, keepdim=True)
    v = x.var(dim=axis, keepdim=True, unbiased=False)
    return (x - m) / torch.sqrt(v + eps)

def _scatter_add(tgt, idx, src, axis=0):
    return tgt.clone().index_add_(axis, idx, src)

def _segment_sum(src, seg, n):
    out = torch.zeros((n,) + src.shape[1:], dtype=src.dtype)
    return out.index_add_(0, seg, src)

def _pad(x, pw):
    flat = tuple((v for pair in reversed(pw) for v in pair))
    return torch.nn.functional.pad(x, flat)
kernel_name = 'adaLN_cond__ssm_conv_h3__dense_activation_silu__prompt'

def setup_inputs():

    _w = lambda a: (lambda t: t.to(torch.bfloat16) if t.is_floating_point() else t)(torch.as_tensor(a))

    def _A_setup():
        B, S, D = (1, 2048, 448)
        ks = 4
        return {'q': _w((lambda *s: torch.randn(*s, dtype=torch.bfloat16) * 0.05)(B, S, D)), 'k': _w((lambda *s: torch.randn(*s, dtype=torch.bfloat16) * 0.8)(B, S, D)), 'v': _w((lambda *s: torch.randn(*s, dtype=torch.bfloat16) * 0.8)(B, S, D)), 'shift_k': _w((lambda *s: torch.randn(*s, dtype=torch.bfloat16) * 0.8)(D, ks) * 0.5), 'ssm_k': _w((lambda *s: torch.randn(*s, dtype=torch.bfloat16) * 0.8)(D, S) * (1.0 / S ** 0.5)), 'ssm_D': _w((lambda *s: torch.randn(*s, dtype=torch.bfloat16) * 0.8)(D))}
    _A_in = _A_setup()

    def _B_setup():
        B, S, D, F = (1, 2048, 448, 1792)
        return {'x': _w((lambda *s: torch.randn(*s, dtype=torch.bfloat16) * 0.05)(B, S, D)), 'w1': _w((lambda *s: torch.randn(*s, dtype=torch.bfloat16) * 3.2)(D, F) * D ** (-0.5)), 'w2': _w((lambda *s: torch.randn(*s, dtype=torch.bfloat16) * 0.8)(F, D) * F ** (-0.5))}
    _B_in = _B_setup()
    return {'A_q': _A_in['q'], 'A_k': _A_in['k'], 'A_v': _A_in['v'], 'A_shift_k': _A_in['shift_k'], 'A_ssm_k': _A_in['ssm_k'], 'A_ssm_D': _A_in['ssm_D'], 'B_x': _B_in['x'], 'B_w1': _B_in['w1'], 'B_w2': _B_in['w2'], 'c': _w((lambda *s: torch.randn(*s, dtype=torch.bfloat16) * 0.2)(1, 448) * 8.0), 'w_mod': _w((lambda *s: torch.randn(*s, dtype=torch.bfloat16) * 0.2)(448, 6 * 448) * 448 ** (-0.5) * 8.0)}

def reference(A_q, A_k, A_v, A_shift_k, A_ssm_k, A_ssm_D, B_x, B_w1, B_w2, c, w_mod):

    def _A_ref(q, k, v, shift_k, ssm_k, ssm_D):
        B, S, D = q.shape
        ks = shift_k.shape[-1]
        k_pad = _pad(k, ((0, 0), (ks - 1, 0), (0, 0)))
        k_shift = torch.zeros_like(k)
        for t in range(ks):
            k_shift = k_shift + k_pad[:, t:t + S, :] * shift_k[:, ks - 1 - t][None, None, :]
        kv = k_shift * v
        L = 2 * S
        kv_pad = _pad(kv, ((0, 0), (0, S), (0, 0)))
        kf_pad = _pad(ssm_k, ((0, 0), (0, S)))
        kv_f = (lambda x, axes=(-2, -1): torch.fft.rfft2(x.float(), dim=axes))(kv_pad[:, None, :, :], axes=(1, 2))
        kf_f = (lambda x, axes=(-2, -1): torch.fft.rfft2(x.float(), dim=axes))(kf_pad[:, None, :], axes=(1, 2))
        kf_f = (lambda x, *d: x.permute(*d))(kf_f, 1, 2, 0)
        y_f = kv_f * kf_f[None, :, :, :]
        y = (lambda x, s, axes=(-2, -1): torch.fft.irfft2(x, s=s, dim=axes).to(torch.bfloat16))(y_f, (1, L), axes=(1, 2))[:, 0, :S, :]
        y = y + kv * ssm_D[None, None, :]
        return q * y

    def _B_ref(x, w1, w2):
        h = torch.einsum('bsd,df->bsf', x, w1)
        h = _silu(h)
        out = torch.einsum('bsf,fd->bsd', h, w2)
        return out
    x = A_q
    mod = (_silu(c) @ w_mod).reshape(c.shape[0], 6, 1, -1)
    sa, ca, ga, sb, cb, gb = (mod[:, 0].clone(), mod[:, 1].clone(), mod[:, 2].clone(), mod[:, 3].clone(), mod[:, 4].clone(), mod[:, 5].clone())
    h = _layernorm(x, axis=-1) * (1 + ca) + sa
    x = x + ga * _A_ref(h, A_k, A_v, A_shift_k, A_ssm_k, A_ssm_D)
    h = _layernorm(x, axis=-1) * (1 + cb) + sb
    x = x + gb * _B_ref(h, B_w1, B_w2)
    return x
```

```asm
; @launch grid=(256,1,1) block=(256,1,1) lds=163328
.amdgcn_target "amdgcn-amd-amdhsa--gfx950"
.text
.globl adaLN_cond__ssm_conv_h3__dense_activation_silu__prompt_kernel
.p2align 8
.type adaLN_cond__ssm_conv_h3__dense_activation_silu__prompt_kernel,@function
adaLN_cond__ssm_conv_h3__dense_activation_silu__prompt_kernel:
    s_getpc_b64 s[62:63]
    s_load_dwordx16 s[4:19], s[0:1], 0
    s_load_dwordx8 s[20:27], s[0:1], 64
    s_load_dwordx4 s[28:31], s[0:1], 96
    v_readfirstlane_b32 s91, v0
    s_mov_b32 s90, 0xffff0000
    s_and_b32 s92, s2, 7
    s_lshr_b32 s93, s2, 3
    s_lshr_b32 s91, s91, 6
    s_cmp_ge_u32 s2, 256
    s_cbranch_scc1 L_end
    s_cmp_eq_u32 s92, 7
    s_cselect_b32 s56, 28, 32
    s_cmp_ge_u32 s93, s56
    s_cbranch_scc1 L_end
    s_getreg_b32 s97, hwreg(HW_REG_XCC_ID, 0, 4)
    v_and_b32 v1, 63, v0
    v_and_b32 v2, 15, v0
    v_bfe_u32 v3, v0, 4, 2
    s_mul_hi_u32 s56, s93, 613566757
    s_mul_i32 s57, s56, 7
    s_sub_u32 s96, s93, s57
    s_min_u32 s56, s56, 3
    s_lshl_b32 s95, s92, 2
    s_add_u32 s95, s95, s56
    s_waitcnt lgkmcnt(0)
    s_add_u32 s52, s30, 4259840
    s_addc_u32 s53, s31, 0
    s_mov_b32 s54, 73728
    s_mov_b32 s55, 0x20000
    s_add_u32 s56, s30, 4259840
    s_addc_u32 s57, s31, 0
    s_load_dwordx2 s[88:89], s[56:57], 0
    s_cmp_eq_u32 s92, 7
    s_cbranch_scc1 L_aux
    s_mov_b32 s32, s6
    s_mov_b32 s33, s7
    s_mov_b32 s34, 1835008
    s_mov_b32 s35, 0x20000
    s_mov_b32 s36, s8
    s_mov_b32 s37, s9
    s_mov_b32 s38, 1835008
    s_mov_b32 s39, 0x20000
    s_mov_b32 s40, s10
    s_mov_b32 s41, s11
    s_mov_b32 s42, 3584
    s_mov_b32 s43, 0x20000
    v_and_b32 v4, 31, v0
    v_lshrrev_b32 v5, 5, v0
    s_mul_i32 s56, s93, 57344
    s_lshl_b32 s57, s92, 7
    s_add_u32 s56, s56, s57
    v_mul_u32_u24 v6, 7168, v5
    v_lshl_add_u32 v6, v4, 2, v6
    v_add_u32 v6, s56, v6
    v_subrev_u32 v7, 2688, v6
    s_movk_i32 s58, 3584
    s_lshl_b32 s59, s92, 9
    v_lshlrev_b32 v8, 4, v4
    v_add_u32 v8, s59, v8
    buffer_load_dword v12, v7, s[32:35], 0 offen offset:0
    buffer_load_dword v13, v7, s[32:35], 0 offen offset:896
    buffer_load_dword v14, v7, s[32:35], 0 offen offset:1792
    buffer_load_dword v15, v6, s[32:35], 0 offen offset:0
    buffer_load_dword v16, v6, s[32:35], 0 offen offset:896
    buffer_load_dword v17, v6, s[32:35], 0 offen offset:1792
    buffer_load_dword v18, v6, s[32:35], 0 offen offset:2688
    buffer_load_dword v19, v6, s[32:35], s58 offen offset:0
    buffer_load_dword v20, v6, s[32:35], s58 offen offset:896
    buffer_load_dword v21, v6, s[32:35], s58 offen offset:1792
    buffer_load_dword v22, v6, s[32:35], s58 offen offset:2688
    buffer_load_dwordx4 v[144:147], v8, s[40:43], 0 offen
    buffer_load_dword v24, v6, s[36:39], 0 offen offset:0
    buffer_load_dword v25, v6, s[36:39], 0 offen offset:896
    buffer_load_dword v26, v6, s[36:39], 0 offen offset:1792
    buffer_load_dword v27, v6, s[36:39], 0 offen offset:2688
    buffer_load_dword v28, v6, s[36:39], s58 offen offset:0
    buffer_load_dword v29, v6, s[36:39], s58 offen offset:896
    buffer_load_dword v30, v6, s[36:39], s58 offen offset:1792
    buffer_load_dword v31, v6, s[36:39], s58 offen offset:2688
    s_sub_u32 s64, s62, 4
    s_subb_u32 s65, s63, 0
    s_mov_b32 s66, (L_code_end - adaLN_cond__ssm_conv_h3__dense_activation_silu__prompt_kernel)
    s_mov_b32 s67, 0x20000
    s_lshl_b32 s56, s93, 2
    s_add_u32 s56, s56, s91
    s_mul_i32 s56, s56, 384
    v_and_b32 v238, 3, v1
    v_lshlrev_b32 v238, 7, v238
    v_add_u32 v238, s56, v238
    s_mov_b64 exec, 7
    buffer_load_dword v239, v238, s[64:67], 0 offen
    s_mov_b64 exec, -1
    s_lshr_b32 s60, s91, 1
    s_and_b32 s61, s91, 1
    s_lshl_b32 s62, s92, 6
    s_lshl_b32 s56, s93, 1
    s_add_u32 s62, s62, s56
    s_add_u32 s62, s62, s60
    s_lshl_b32 s63, s62, 12
    s_add_u32 s44, s12, s63
    s_addc_u32 s45, s13, 0
    s_mov_b32 s46, 4096
    s_mov_b32 s47, 0x20000
    s_mov_b32 s48, s14
    s_mov_b32 s49, s15
    s_mov_b32 s50, 896
    s_mov_b32 s51, 0x20000
    s_lshl_b32 s56, s61, 11
    v_lshlrev_b32 v9, 4, v1
    v_add_u32 v92, s56, v9
    v_sub_u32 v93, 4080, v92
    v_sub_u32 v94, 3056, v92
    v_subrev_u32 v95, 8, v93
    v_subrev_u32 v141, 8, v94
    s_lshl_b32 s56, s62, 1
    v_mov_b32 v142, s56
    s_mov_b32 s40, s30
    s_mov_b32 s41, s31
    s_mov_b32 s42, 1835008
    s_mov_b32 s43, 0x20000
    s_waitcnt lgkmcnt(0)
    s_add_u32 s88, s88, 1
    s_addc_u32 s89, s89, 0
    s_cmp_lg_u32 s91, 0
    s_cbranch_scc1 L_w0_1
    s_andn2_b32 s56, s89, 15
    s_or_b32 s56, s56, s97
    s_lshl_b32 s57, s2, 6
    s_add_u32 s57, s57, 4096
    v_mov_b32 v250, s57
    v_mov_b32 v252, s88
    v_mov_b32 v253, s56
    s_mov_b64 exec, 1
    buffer_store_dwordx2 v[252:253], v250, s[52:55], 0 offen sc1
    s_lshl_b32 s57, s92, 5
    s_add_u32 s57, s57, s93
    s_lshl_b32 s57, s57, 6
    s_add_u32 s57, s57, 20480
    s_mul_i32 s56, s95, 7
    s_add_u32 s56, s56, s96
    s_lshl_b32 s56, s56, 6
    s_add_u32 s56, s56, 57344
    s_mov_b64 exec, 3
    v_mov_b32 v250, s57
    v_writelane_b32 v250, s56, 1
    buffer_load_dword v251, v250, s[52:55], 0 offen sc1
    s_mov_b64 exec, -1
L_w0_1:
    v_mul_u32_u24 v10, 144, v4
    v_lshl_add_u32 v10, v5, 4, v10
    v_add_u32 v10, 33280, v10
    v_lshrrev_b32 v11, 3, v0
    v_and_b32 v23, 1, v11
    v_lshlrev_b32 v23, 5, v23
    v_lshrrev_b32 v62, 1, v11
    v_add_u32 v23, v23, v62
    v_mul_u32_u24 v23, 144, v23
    v_and_b32 v62, 7, v0
    v_lshl_add_u32 v23, v62, 4, v23
    v_add_u32 v23, 33280, v23
    s_lshl_b32 s56, s92, 18
    s_lshl_b32 s57, s93, 7
    s_add_u32 s56, s56, s57
    v_lshlrev_b32 v11, 12, v11
    v_lshl_add_u32 v11, v62, 4, v11
    v_add_u32 v11, s56, v11
    s_mov_b32 s98, 131072
    s_waitcnt vmcnt(9)
    s_lshl_b32 s56, s92, 6
    s_lshl_b32 s57, s91, 4
    s_add_u32 s56, s56, s57
    s_lshl_b32 s56, s56, 12
    s_lshl_b32 s57, s93, 7
    s_add_u32 s56, s56, s57
    v_lshlrev_b32 v143, 12, v2
    v_add_u32 v143, s56, v143
    s_mov_b64 exec, 0xffff
    buffer_load_dword v254, v143, s[40:43], 0 offen sc1
    s_mov_b64 exec, -1
    buffer_load_dwordx4 v[96:99], v93, s[44:47], 0 offen
    buffer_load_dwordx2 v[100:101], v95, s[44:47], 0 offen
    buffer_load_dwordx4 v[104:107], v94, s[44:47], 0 offen
    buffer_load_dwordx2 v[102:103], v141, s[44:47], 0 offen
    buffer_load_ushort v140, v142, s[48:51], 0 offen
    v_lshlrev_b32 v32, 16, v144
    v_and_b32 v34, s90, v144
    v_lshlrev_b32 v36, 16, v145
    v_and_b32 v38, s90, v145
    v_lshlrev_b32 v33, 16, v146
    v_and_b32 v35, s90, v146
    v_lshlrev_b32 v37, 16, v147
    v_and_b32 v39, s90, v147
    v_lshlrev_b32 v40, 16, v12
    v_and_b32 v41, s90, v12
    v_lshlrev_b32 v42, 16, v13
    v_and_b32 v43, s90, v13
    v_lshlrev_b32 v44, 16, v14
    v_and_b32 v45, s90, v14
    v_lshlrev_b32 v46, 16, v15
    v_and_b32 v47, s90, v15
    v_lshlrev_b32 v48, 16, v16
    v_and_b32 v49, s90, v16
    v_lshlrev_b32 v50, 16, v17
    v_and_b32 v51, s90, v17
    v_lshlrev_b32 v52, 16, v18
    v_and_b32 v53, s90, v18
    v_lshlrev_b32 v54, 16, v19
    v_and_b32 v55, s90, v19
    v_lshlrev_b32 v56, 16, v20
    v_and_b32 v57, s90, v20
    v_lshlrev_b32 v58, 16, v21
    v_and_b32 v59, s90, v21
    v_lshlrev_b32 v60, 16, v22
    v_and_b32 v61, s90, v22
    v_pk_mul_f32 v[64:65], v[40:41], v[38:39]
    v_pk_fma_f32 v[64:65], v[42:43], v[36:37], v[64:65]
    v_pk_fma_f32 v[64:65], v[44:45], v[34:35], v[64:65]
    v_pk_fma_f32 v[64:65], v[46:47], v[32:33], v[64:65]
    v_pk_mul_f32 v[66:67], v[42:43], v[38:39]
    v_pk_fma_f32 v[66:67], v[44:45], v[36:37], v[66:67]
    v_pk_fma_f32 v[66:67], v[46:47], v[34:35], v[66:67]
    v_pk_fma_f32 v[66:67], v[48:49], v[32:33], v[66:67]
    v_pk_mul_f32 v[68:69], v[44:45], v[38:39]
    v_pk_fma_f32 v[68:69], v[46:47], v[36:37], v[68:69]
    v_pk_fma_f32 v[68:69], v[48:49], v[34:35], v[68:69]
    v_pk_fma_f32 v[68:69], v[50:51], v[32:33], v[68:69]
    v_pk_mul_f32 v[70:71], v[46:47], v[38:39]
    v_pk_fma_f32 v[70:71], v[48:49], v[36:37], v[70:71]
    v_pk_fma_f32 v[70:71], v[50:51], v[34:35], v[70:71]
    v_pk_fma_f32 v[70:71], v[52:53], v[32:33], v[70:71]
    v_pk_mul_f32 v[72:73], v[48:49], v[38:39]
    v_pk_fma_f32 v[72:73], v[50:51], v[36:37], v[72:73]
    v_pk_fma_f32 v[72:73], v[52:53], v[34:35], v[72:73]
    v_pk_fma_f32 v[72:73], v[54:55], v[32:33], v[72:73]
    v_pk_mul_f32 v[74:75], v[50:51], v[38:39]
    v_pk_fma_f32 v[74:75], v[52:53], v[36:37], v[74:75]
    v_pk_fma_f32 v[74:75], v[54:55], v[34:35], v[74:75]
    v_pk_fma_f32 v[74:75], v[56:57], v[32:33], v[74:75]
    v_pk_mul_f32 v[76:77], v[52:53], v[38:39]
    v_pk_fma_f32 v[76:77], v[54:55], v[36:37], v[76:77]
    v_pk_fma_f32 v[76:77], v[56:57], v[34:35], v[76:77]
    v_pk_fma_f32 v[76:77], v[58:59], v[32:33], v[76:77]
    v_pk_mul_f32 v[78:79], v[54:55], v[38:39]
    v_pk_fma_f32 v[78:79], v[56:57], v[36:37], v[78:79]
    v_pk_fma_f32 v[78:79], v[58:59], v[34:35], v[78:79]
    v_pk_fma_f32 v[78:79], v[60:61], v[32:33], v[78:79]
    s_mov_b32 s32, s4
    s_mov_b32 s33, s5
    s_mov_b32 s34, 1835008
    s_mov_b32 s35, 0x20000
    s_mov_b32 s36, s18
    s_mov_b32 s37, s19
    s_mov_b32 s38, 1605632
    s_mov_b32 s39, 0x20000
    s_mul_i32 s70, s91, 24576
    s_add_u32 s70, s70, 60928
    v_lshrrev_b32 v200, 3, v1
    v_and_b32 v201, 7, v1
    v_and_b32 v208, 1, v3
    v_lshlrev_b32 v208, 1, v208
    v_xor_b32 v201, v201, v208
    v_lshlrev_b32 v201, 4, v201
    v_mul_u32_u24 v202, 3584, v200
    s_lshl_b32 s56, s96, 9
    s_lshl_b32 s57, s91, 7
    s_add_u32 s56, s56, s57
    v_add_u32 v202, s56, v202
    v_xor_b32 v208, 64, v201
    v_add_u32 v203, v202, v208
    v_add_u32 v202, v202, v201
    v_add_u32 v203, 27648, v203
    s_lshl_b32 s56, s95, 6
    s_lshl_b32 s57, s91, 4
    s_add_u32 s56, s56, s57
    s_mul_i32 s56, s56, 896
    v_lshrrev_b32 v208, 1, v200
    v_and_b32 v209, 7, v1
    v_xor_b32 v208, v208, v209
    v_lshlrev_b32 v208, 4, v208
    v_mul_u32_u24 v204, 896, v200
    v_add_u32 v204, s56, v204
    v_xor_b32 v209, 64, v208
    v_add_u32 v205, v204, v209
    v_add_u32 v205, 7168, v205
    v_add_u32 v204, v204, v208
    v_lshrrev_b32 v208, 1, v2
    v_xor_b32 v208, v208, v3
    v_lshlrev_b32 v208, 4, v208
    v_and_b32 v209, 7, v2
    v_lshl_add_u32 v208, v209, 7, v208
    v_lshrrev_b32 v209, 3, v2
    v_lshl_add_u32 v208, v209, 10, v208
    v_add_u32 v206, s70, v208
    v_xor_b32 v207, 64, v206
    s_mul_i32 s64, s60, 16640
    s_mov_b32 s65, 0xffff
    v_add_u32 v92, s64, v92
    v_lshrrev_b32 v12, 2, v1
    v_mul_u32_u24 v12, 4160, v12
    v_and_b32 v13, 3, v1
    v_lshl_add_u32 v12, v13, 4, v12
    s_add_u32 s56, s64, 4096
    v_add_u32 v12, s56, v12
    s_mul_i32 s66, s60, 4608
    s_add_u32 s66, s66, 33280
    v_add_u32 v13, s66, v9
    s_add_u32 s44, s30, 2097152
    s_addc_u32 s45, s31, 0
    s_mov_b32 s46, 1835008
    s_mov_b32 s47, 0x20000
    v_and_b32 v33, 3, v2
    v_sub_u32 v33, 3, v33
    v_mul_u32_u24 v33, 4160, v33
    v_lshrrev_b32 v34, 2, v2
    v_lshlrev_b32 v34, 3, v34
    v_sub_u32 v33, v33, v34
    v_lshl_add_u32 v33, v3, 4, v33
    s_lshl_b32 s67, s61, 8
    s_add_u32 s56, s64, 280
    s_sub_u32 s56, s56, s67
    v_add_u32 v33, s56, v33
    v_lshlrev_b32 v34, 5, v2
    v_lshl_add_u32 v34, v3, 4, v34
    s_add_u32 s56, s66, 256
    s_sub_u32 s56, s56, s67
    v_add_u32 v34, s56, v34
    s_lshl_b32 s68, s61, 11
    s_add_u32 s69, s63, s68
    s_lshl_b32 s56, s92, 5
    v_and_b32 v35, 31, v1
    v_add_u32 v35, s56, v35
    v_lshlrev_b32 v35, 6, v35
    v_add_u32 v35, 20480, v35
    s_waitcnt vmcnt(7)
    s_cmp_eq_u32 s92, 7
    s_cselect_b32 s57, 27, 31
    v_min_u32 v244, s57, v1
    v_lshlrev_b32 v244, 3, v244
    v_add_u32 v244, s92, v244
    v_lshlrev_b32 v244, 6, v244
    v_add_u32 v244, 4096, v244
    s_cmp_lg_u32 s91, 0
    s_cbranch_scc1 L_w0_2
    buffer_load_dwordx2 v[240:241], v244, s[52:55], 0 offen sc1
L_w0_2:
    v_lshlrev_b32 v80, 16, v24
    v_and_b32 v81, s90, v24
    v_pk_mul_f32 v[64:65], v[64:65], v[80:81]
    v_lshlrev_b32 v82, 16, v25
    v_and_b32 v83, s90, v25
    v_pk_mul_f32 v[66:67], v[66:67], v[82:83]
    v_lshlrev_b32 v80, 16, v26
    v_and_b32 v81, s90, v26
    v_pk_mul_f32 v[68:69], v[68:69], v[80:81]
    v_lshlrev_b32 v82, 16, v27
    v_and_b32 v83, s90, v27
    v_pk_mul_f32 v[70:71], v[70:71], v[82:83]
    v_lshlrev_b32 v80, 16, v28
    v_and_b32 v81, s90, v28
    v_pk_mul_f32 v[72:73], v[72:73], v[80:81]
    v_lshlrev_b32 v82, 16, v29
    v_and_b32 v83, s90, v29
    v_pk_mul_f32 v[74:75], v[74:75], v[82:83]
    v_lshlrev_b32 v80, 16, v30
    v_and_b32 v81, s90, v30
    v_pk_mul_f32 v[76:77], v[76:77], v[80:81]
    v_lshlrev_b32 v82, 16, v31
    v_and_b32 v83, s90, v31
    v_pk_mul_f32 v[78:79], v[78:79], v[82:83]
    v_cvt_pk_bf16_f32 v84, v64, v66
    v_cvt_pk_bf16_f32 v88, v65, v67
    v_cvt_pk_bf16_f32 v85, v68, v70
    v_cvt_pk_bf16_f32 v89, v69, v71
    v_cvt_pk_bf16_f32 v86, v72, v74
    v_cvt_pk_bf16_f32 v90, v73, v75
    v_cvt_pk_bf16_f32 v87, v76, v78
    v_cvt_pk_bf16_f32 v91, v77, v79
    ds_write_b128 v10, v[84:87]
    ds_write_b128 v10, v[88:91] offset:4608
    s_waitcnt lgkmcnt(0)
    s_barrier
    ds_read_b128 v[64:67], v23
    ds_read_b128 v[68:71], v23 offset:2304
    s_waitcnt lgkmcnt(1)
    buffer_store_dwordx4 v[64:67], v11, s[40:43], 0 offen nt
    s_waitcnt lgkmcnt(0)
    buffer_store_dwordx4 v[68:71], v11, s[40:43], s98 offen nt
    s_cmp_lg_u32 s91, 0
    s_cbranch_scc1 L_w0_3
    s_waitcnt vmcnt(2)
L_w0_3:
    s_cmp_lg_u32 s91, 0
    s_cbranch_scc1 L_w0_4
    s_or_b32 s59, s89, 15
    s_mov_b32 s58, s88
    s_mov_b32 s56, 0
    s_branch L_pxf_7
L_px_5:
    buffer_load_dwordx2 v[240:241], v244, s[52:55], 0 offen sc1
    s_waitcnt vmcnt(0)
L_pxf_7:
    v_or_b32 v243, 15, v241
    v_mov_b32 v242, v240
    v_cmp_ne_u64 vcc, s[58:59], v[242:243]
    s_cmp_eq_u64 vcc, 0
    s_cbranch_scc1 L_pxd_6
    s_add_u32 s56, s56, 1
    s_cmp_lt_u32 s56, 131072
    s_cbranch_scc1 L_px_5
L_pxd_6:
    v_and_b32 v241, 15, v241
    v_cmp_ne_u32 vcc, s97, v241
    s_cmp_eq_u64 vcc, 0
    s_cselect_b32 s57, 1, 0
    s_cmp_lt_u32 s56, 131072
    s_cselect_b32 s57, s57, 0
    s_mov_b32 s94, s57
    v_mov_b32 v240, s57
    v_mov_b32 v241, 163312
    ds_write_b32 v241, v240
    s_waitcnt lgkmcnt(0)
L_w0_4:
    s_waitcnt vmcnt(0)
    s_barrier
    s_lshl_b32 s57, s92, 5
    s_add_u32 s57, s57, s93
    s_lshl_b32 s57, s57, 6
    s_cmp_lg_u32 s91, 0
    s_cbranch_scc1 L_w0_8
    s_cmp_eq_u32 s94, 1
    s_cbranch_scc0 L_w0_8
    s_add_u32 s56, s57, 20480
    v_mov_b32 v250, s56
    v_mov_b32 v252, s88
    v_mov_b32 v253, s89
    s_mov_b64 exec, 1
    buffer_store_dwordx2 v[252:253], v250, s[52:55], 0 offen
    s_mov_b64 exec, -1
L_w0_8:
    v_mov_b32 v241, 163312
    ds_read_b32 v240, v241
    s_waitcnt lgkmcnt(0)
    v_readfirstlane_b32 s94, v240
    s_cmp_eq_u32 s94, 1
    s_cbranch_scc1 L_pure1_10
    buffer_store_dwordx4 v[64:67], v11, s[40:43], 0 offen sc1
    buffer_store_dwordx4 v[68:71], v11, s[40:43], s98 offen sc1
    s_waitcnt vmcnt(0)
    s_barrier
    s_cmp_lg_u32 s91, 0
    s_cbranch_scc1 L_w0_11
    s_add_u32 s56, s57, 20480
    v_mov_b32 v250, s56
    v_mov_b32 v252, s88
    v_mov_b32 v253, s89
    s_mov_b64 exec, 1
    buffer_store_dwordx2 v[252:253], v250, s[52:55], 0 offen sc1
    s_mov_b64 exec, -1
L_w0_11:
L_pure1_10:
    s_lshl_b32 s56, s92, 5
    s_add_u32 s56, s56, s93
    s_mul_i32 s59, s56, 7168
    v_min_u32 v248, 55, v1
    v_lshlrev_b32 v248, 7, v248
    s_mov_b32 s48, s18
    s_mov_b32 s49, s19
    s_mov_b32 s50, 1605632
    s_mov_b32 s51, 0x20000
    s_cmp_eq_u32 s91, 2
    s_cbranch_scc0 L_wtd_12
    buffer_load_dword v255, v248, s[48:51], s59 offen
L_wtd_12:
    s_mov_b32 s48, s4
    s_mov_b32 s49, s5
    s_mov_b32 s50, 1835008
    s_mov_b32 s51, 0x20000
    s_mul_i32 s56, s92, 229376
    s_mul_i32 s57, s93, 7168
    s_add_u32 s58, s56, s57
    v_min_u32 v248, 55, v1
    v_lshlrev_b32 v248, 7, v248
    s_cmp_eq_u32 s91, 1
    s_cbranch_scc0 L_wq_13
    buffer_load_dword v255, v248, s[48:51], s58 offen
L_wq_13:
    v_alignbit_b32 v108, v99, v99, 16
    v_alignbit_b32 v109, v98, v98, 16
    v_alignbit_b32 v110, v97, v97, 16
    v_alignbit_b32 v111, v96, v96, 16
    ds_write_b128 v92, v[108:111] offset:0
    v_bfi_b32 v112, s65, v99, v98
    v_bfi_b32 v113, s65, v98, v97
    v_bfi_b32 v114, s65, v97, v96
    v_bfi_b32 v115, s65, v96, v101
    ds_write_b128 v92, v[112:115] offset:4160
    v_alignbit_b32 v116, v98, v98, 16
    v_alignbit_b32 v117, v97, v97, 16
    v_alignbit_b32 v118, v96, v96, 16
    v_alignbit_b32 v119, v101, v101, 16
    ds_write_b128 v92, v[116:119] offset:8320
    v_bfi_b32 v120, s65, v98, v97
    v_bfi_b32 v121, s65, v97, v96
    v_bfi_b32 v122, s65, v96, v101
    v_bfi_b32 v123, s65, v101, v100
    ds_write_b128 v92, v[120:123] offset:12480
    v_alignbit_b32 v124, v107, v107, 16
    v_alignbit_b32 v125, v106, v106, 16
    v_alignbit_b32 v126, v105, v105, 16
    v_alignbit_b32 v127, v104, v104, 16
    ds_write_b128 v92, v[124:127] offset:1024
    v_bfi_b32 v128, s65, v107, v106
    v_bfi_b32 v129, s65, v106, v105
    v_bfi_b32 v130, s65, v105, v104
    v_bfi_b32 v131, s65, v104, v103
    ds_write_b128 v92, v[128:131] offset:5184
    v_alignbit_b32 v132, v106, v106, 16
    v_alignbit_b32 v133, v105, v105, 16
    v_alignbit_b32 v134, v104, v104, 16
    v_alignbit_b32 v135, v103, v103, 16
    ds_write_b128 v92, v[132:135] offset:9344
    v_bfi_b32 v136, s65, v106, v105
    v_bfi_b32 v137, s65, v105, v104
    v_bfi_b32 v138, s65, v104, v103
    v_bfi_b32 v139, s65, v103, v102
    ds_write_b128 v92, v[136:139] offset:13504
    v_mov_b32 v28, 0
    v_mov_b32 v29, 0
    v_mov_b32 v30, 0
    v_mov_b32 v31, 0
    s_cmp_eq_u32 s61, 0
    s_cbranch_scc0 L_nz_14
    s_mov_b64 exec, 0xffff
    ds_write_b128 v12, v[28:31]
    s_mov_b64 exec, 0x3fffffff
    ds_write_b128 v13, v[28:31]
    s_mov_b64 exec, -1
L_nz_14:
    s_cmp_lg_u32 s91, 0
    s_cbranch_scc1 L_w0_15
    s_mov_b32 s56, 0
L_poll_16:
    buffer_load_dwordx2 v[240:241], v35, s[52:55], 0 offen sc1
    s_waitcnt vmcnt(0)
L_pfirst_18:
    v_cmp_ne_u64 vcc, s[88:89], v[240:241]
    s_cmp_eq_u64 vcc, 0
    s_cbranch_scc1 L_pdone_17
    s_add_u32 s56, s56, 1
    s_cmp_lt_u32 s56, 131072
    s_cbranch_scc1 L_poll_16
L_pdone_17:
L_w0_15:
    s_barrier
    s_cmp_lg_u32 s91, 0
    s_cbranch_scc1 L_w0_19
    s_mov_b32 m0, 33760
    s_add_u32 s57, s63, 0
    buffer_load_dwordx4 v9, s[40:43], s57 offen offset:0 sc1 lds
    buffer_load_dwordx4 v9, s[40:43], s57 offen offset:1024 sc1 lds
    buffer_load_dwordx4 v9, s[40:43], s57 offen offset:2048 sc1 lds
    buffer_load_dwordx4 v9, s[40:43], s57 offen offset:3072 sc1 lds
    s_mov_b32 m0, 38368
    s_add_u32 s57, s63, 4096
    buffer_load_dwordx4 v9, s[40:43], s57 offen offset:0 sc1 lds
    buffer_load_dwordx4 v9, s[40:43], s57 offen offset:1024 sc1 lds
    buffer_load_dwordx4 v9, s[40:43], s57 offen offset:2048 sc1 lds
    buffer_load_dwordx4 v9, s[40:43], s57 offen offset:3072 sc1 lds
    s_waitcnt vmcnt(0)
L_w0_19:
    s_waitcnt lgkmcnt(0)
    s_barrier
    s_lshl_b32 s56, s92, 6
    s_lshl_b32 s57, s93, 1
    s_add_u32 s56, s56, s57
    s_lshl_b32 s56, s56, 12
    v_lshlrev_b32 v248, 7, v1
    s_cmp_eq_u32 s91, 3
    s_cbranch_scc0 L_pty_20
    buffer_load_dword v255, v248, s[44:47], s56 offen sc1
L_pty_20:
    s_cmp_ge_u32 s93, 28
    s_cbranch_scc1 L_convb_21
    ds_read_b128 a[64:67], v34 offset:192
    ds_read_b64 a[0:1], v33 offset:3776
    ds_read_b64 a[2:3], v33 offset:3784
    ds_read_b128 a[68:71], v34 offset:704
    ds_read_b64 a[4:5], v33 offset:3264
    ds_read_b64 a[6:7], v33 offset:3272
    ds_read_b128 a[72:75], v34 offset:1216
    ds_read_b64 a[8:9], v33 offset:2752
    ds_read_b64 a[10:11], v33 offset:2760
    ds_read_b128 a[76:79], v34 offset:1728
    ds_read_b64 a[12:13], v33 offset:2240
    ds_read_b64 a[14:15], v33 offset:2248
    ds_read_b128 a[80:83], v34 offset:2240
    ds_read_b64 a[16:17], v33 offset:1728
    ds_read_b64 a[18:19], v33 offset:1736
    ds_read_b128 a[84:87], v34 offset:2752
    ds_read_b64 a[20:21], v33 offset:1216
    ds_read_b64 a[22:23], v33 offset:1224
    ds_read_b128 a[88:91], v34 offset:3264
    ds_read_b64 a[24:25], v33 offset:704
    ds_read_b64 a[26:27], v33 offset:712
    ds_read_b128 a[92:95], v34 offset:3776
    ds_read_b64 a[28:29], v33 offset:192
    ds_read_b64 a[30:31], v33 offset:200
    s_waitcnt lgkmcnt(0)
    v_mfma_f32_16x16x32_bf16 v[96:99], a[0:3], a[64:67], 0
    ds_read_b128 a[96:99], v34 offset:128
    v_mfma_f32_16x16x32_bf16 v[100:103], a[0:3], a[68:71], 0
    ds_read_b64 a[32:33], v33 offset:3712
    s_add_u32 m0, s70, 0
    s_movk_i32 s71, 0
    buffer_load_dwordx4 v204, s[32:35], s71 offen lds
    v_mfma_f32_16x16x32_bf16 v[100:103], a[4:7], a[64:67], v[100:103]
    ds_read_b64 a[34:35], v33 offset:3720
    v_mfma_f32_16x16x32_bf16 v[104:107], a[4:7], a[68:71], 0
    ds_read_b128 a[100:103], v34 offset:640
    s_add_u32 m0, s70, 1024
    s_movk_i32 s71, 0
    buffer_load_dwordx4 v205, s[32:35], s71 offen lds
    v_mfma_f32_16x16x32_bf16 v[104:107], a[0:3], a[72:75], v[104:107]
    ds_read_b64 a[36:37], v33 offset:3200
    v_mfma_f32_16x16x32_bf16 v[108:111], a[4:7], a[72:75], 0
    ds_read_b64 a[38:39], v33 offset:3208
    v_mfma_f32_16x16x32_bf16 v[104:107], a[8:11], a[64:67], v[104:107]
    ds_read_b128 a[104:107], v34 offset:1152
    s_add_u32 m0, s70, 2048
    s_movk_i32 s71, 128
    buffer_load_dwordx4 v204, s[32:35], s71 offen lds
    v_mfma_f32_16x16x32_bf16 v[108:111], a[8:11], a[68:71], v[108:111]
    ds_read_b64 a[40:41], v33 offset:2688
    v_mfma_f32_16x16x32_bf16 v[112:115], a[8:11], a[72:75], 0
    ds_read_b64 a[42:43], v33 offset:2696
    s_add_u32 m0, s70, 3072
    s_movk_i32 s71, 128
    buffer_load_dwordx4 v205, s[32:35], s71 offen lds
    v_mfma_f32_16x16x32_bf16 v[108:111], a[0:3], a[76:79], v[108:111]
    ds_read_b128 a[108:111], v34 offset:1664
    v_mfma_f32_16x16x32_bf16 v[112:115], a[4:7], a[76:79], v[112:115]
    ds_read_b64 a[44:45], v33 offset:2176
    v_mfma_f32_16x16x32_bf16 v[116:119], a[8:11], a[76:79], 0
    ds_read_b64 a[46:47], v33 offset:2184
    s_add_u32 m0, s70, 4096
    s_movk_i32 s71, 256
    buffer_load_dwordx4 v204, s[32:35], s71 offen lds
    v_mfma_f32_16x16x32_bf16 v[108:111], a[12:15], a[64:67], v[108:111]
    ds_read_b128 a[112:115], v34 offset:2176
    v_mfma_f32_16x16x32_bf16 v[112:115], a[12:15], a[68:71], v[112:115]
    ds_read_b64 a[48:49], v33 offset:1664
    s_add_u32 m0, s70, 5120
    s_movk_i32 s71, 256
    buffer_load_dwordx4 v205, s[32:35], s71 offen lds
    v_mfma_f32_16x16x32_bf16 v[116:119], a[12:15], a[72:75], v[116:119]
    ds_read_b64 a[50:51], v33 offset:1672
    v_mfma_f32_16x16x32_bf16 v[120:123], a[12:15], a[76:79], 0
    ds_read_b128 a[116:119], v34 offset:2688
    v_mfma_f32_16x16x32_bf16 v[112:115], a[0:3], a[80:83], v[112:115]
    ds_read_b64 a[52:53], v33 offset:1152
    s_add_u32 m0, s70, 6144
    s_movk_i32 s71, 384
    buffer_load_dwordx4 v204, s[32:35], s71 offen lds
    v_mfma_f32_16x16x32_bf16 v[116:119], a[4:7], a[80:83], v[116:119]
    ds_read_b64 a[54:55], v33 offset:1160
    v_mfma_f32_16x16x32_bf16 v[120:123], a[8:11], a[80:83], v[120:123]
    ds_read_b128 a[120:123], v34 offset:3200
    s_add_u32 m0, s70, 7168
    s_movk_i32 s71, 384
    buffer_load_dwordx4 v205, s[32:35], s71 offen lds
    v_mfma_f32_16x16x32_bf16 v[124:127], a[12:15], a[80:83], 0
    ds_read_b64 a[56:57], v33 offset:640
    v_mfma_f32_16x16x32_bf16 v[112:115], a[16:19], a[64:67], v[112:115]
    ds_read_b64 a[58:59], v33 offset:648
    v_mfma_f32_16x16x32_bf16 v[116:119], a[16:19], a[68:71], v[116:119]
    ds_read_b128 a[124:127], v34 offset:3712
    s_add_u32 m0, s70, 8192
    s_movk_i32 s71, 512
    buffer_load_dwordx4 v204, s[32:35], s71 offen lds
    v_mfma_f32_16x16x32_bf16 v[120:123], a[16:19], a[72:75], v[120:123]
    ds_read_b64 a[60:61], v33 offset:128
    v_mfma_f32_16x16x32_bf16 v[124:127], a[16:19], a[76:79], v[124:127]
    ds_read_b64 a[62:63], v33 offset:136
    s_add_u32 m0, s70, 9216
    s_movk_i32 s71, 512
    buffer_load_dwordx4 v205, s[32:35], s71 offen lds
    v_mfma_f32_16x16x32_bf16 v[116:119], a[0:3], a[84:87], v[116:119]
    v_mfma_f32_16x16x32_bf16 v[120:123], a[4:7], a[84:87], v[120:123]
    v_mfma_f32_16x16x32_bf16 v[124:127], a[8:11], a[84:87], v[124:127]
    s_add_u32 m0, s70, 10240
    s_movk_i32 s71, 640
    buffer_load_dwordx4 v204, s[32:35], s71 offen lds
    v_mfma_f32_16x16x32_bf16 v[116:119], a[20:23], a[64:67], v[116:119]
    v_mfma_f32_16x16x32_bf16 v[120:123], a[20:23], a[68:71], v[120:123]
    s_add_u32 m0, s70, 11264
    s_movk_i32 s71, 640
    buffer_load_dwordx4 v205, s[32:35], s71 offen lds
    v_mfma_f32_16x16x32_bf16 v[124:127], a[20:23], a[72:75], v[124:127]
    v_mfma_f32_16x16x32_bf16 v[120:123], a[0:3], a[88:91], v[120:123]
    v_mfma_f32_16x16x32_bf16 v[124:127], a[4:7], a[88:91], v[124:127]
    s_add_u32 m0, s70, 12288
    s_movk_i32 s71, 768
    buffer_load_dwordx4 v204, s[32:35], s71 offen lds
    v_mfma_f32_16x16x32_bf16 v[120:123], a[24:27], a[64:67], v[120:123]
    v_mfma_f32_16x16x32_bf16 v[124:127], a[24:27], a[68:71], v[124:127]
    s_add_u32 m0, s70, 13312
    s_movk_i32 s71, 768
    buffer_load_dwordx4 v205, s[32:35], s71 offen lds
    v_mfma_f32_16x16x32_bf16 v[124:127], a[0:3], a[92:95], v[124:127]
    v_mfma_f32_16x16x32_bf16 v[124:127], a[28:31], a[64:67], v[124:127]
    s_waitcnt lgkmcnt(0)
    v_add_u32 v204, 55296, v202
    v_add_u32 v205, 55296, v203
    v_mfma_f32_16x16x32_bf16 v[96:99], a[32:35], a[96:99], v[96:99]
    ds_read_b128 a[64:67], v34 offset:64
    v_mfma_f32_16x16x32_bf16 v[100:103], a[32:35], a[100:103], v[100:103]
    ds_read_b64 a[0:1], v33 offset:3648
    v_mfma_f32_16x16x32_bf16 v[100:103], a[36:39], a[96:99], v[100:103]
    ds_read_b64 a[2:3], v33 offset:3656
    s_add_u32 m0, s70, 16384
    s_mov_b32 s71, 0
    buffer_load_dwordx4 v202, s[36:39], s71 offen offset:0 lds
    v_mfma_f32_16x16x32_bf16 v[104:107], a[36:39], a[100:103], v[104:107]
    ds_read_b128 a[68:71], v34 offset:576
    v_mfma_f32_16x16x32_bf16 v[104:107], a[32:35], a[104:107], v[104:107]
    ds_read_b64 a[4:5], v33 offset:3136
    v_mfma_f32_16x16x32_bf16 v[108:111], a[36:39], a[104:107], v[108:111]
    ds_read_b64 a[6:7], v33 offset:3144
    v_mfma_f32_16x16x32_bf16 v[104:107], a[40:43], a[96:99], v[104:107]
    ds_read_b128 a[72:75], v34 offset:1088
    buffer_load_dwordx4 v203, s[36:39], s71 offen offset:1024 lds
    v_mfma_f32_16x16x32_bf16 v[108:111], a[40:43], a[100:103], v[108:111]
    ds_read_b64 a[8:9], v33 offset:2624
    v_mfma_f32_16x16x32_bf16 v[112:115], a[40:43], a[104:107], v[112:115]
    ds_read_b64 a[10:11], v33 offset:2632
    v_mfma_f32_16x16x32_bf16 v[108:111], a[32:35], a[108:111], v[108:111]
    ds_read_b128 a[76:79], v34 offset:1600
    v_mfma_f32_16x16x32_bf16 v[112:115], a[36:39], a[108:111], v[112:115]
    ds_read_b64 a[12:13], v33 offset:2112
    buffer_load_dwordx4 v204, s[36:39], s71 offen offset:2048 lds
    v_mfma_f32_16x16x32_bf16 v[116:119], a[40:43], a[108:111], v[116:119]
    ds_read_b64 a[14:15], v33 offset:2120
    v_mfma_f32_16x16x32_bf16 v[108:111], a[44:47], a[96:99], v[108:111]
    ds_read_b128 a[80:83], v34 offset:2112
    v_mfma_f32_16x16x32_bf16 v[112:115], a[44:47], a[100:103], v[112:115]
    ds_read_b64 a[16:17], v33 offset:1600
    v_mfma_f32_16x16x32_bf16 v[116:119], a[44:47], a[104:107], v[116:119]
    ds_read_b64 a[18:19], v33 offset:1608
    buffer_load_dwordx4 v205, s[36:39], s71 offen offset:3072 lds
    v_mfma_f32_16x16x32_bf16 v[120:123], a[44:47], a[108:111], v[120:123]
    ds_read_b128 a[84:87], v34 offset:2624
    v_mfma_f32_16x16x32_bf16 v[112:115], a[32:35], a[112:115], v[112:115]
    ds_read_b64 a[20:21], v33 offset:1088
    v_mfma_f32_16x16x32_bf16 v[116:119], a[36:39], a[112:115], v[116:119]
    ds_read_b64 a[22:23], v33 offset:1096
    v_mfma_f32_16x16x32_bf16 v[120:123], a[40:43], a[112:115], v[120:123]
    ds_read_b128 a[88:91], v34 offset:3136
    s_add_u32 m0, s70, 20480
    s_mov_b32 s71, 114688
    buffer_load_dwordx4 v202, s[36:39], s71 offen offset:0 lds
    v_mfma_f32_16x16x32_bf16 v[124:127], a[44:47], a[112:115], v[124:127]
    ds_read_b64 a[24:25], v33 offset:576
    v_mfma_f32_16x16x32_bf16 v[112:115], a[48:51], a[96:99], v[112:115]
    ds_read_b64 a[26:27], v33 offset:584
    v_mfma_f32_16x16x32_bf16 v[116:119], a[48:51], a[100:103], v[116:119]
    ds_read_b128 a[92:95], v34 offset:3648
    v_mfma_f32_16x16x32_bf16 v[120:123], a[48:51], a[104:107], v[120:123]
    ds_read_b64 a[28:29], v33 offset:64
    buffer_load_dwordx4 v203, s[36:39], s71 offen offset:1024 lds
    v_mfma_f32_16x16x32_bf16 v[124:127], a[48:51], a[108:111], v[124:127]
    ds_read_b64 a[30:31], v33 offset:72
    v_mfma_f32_16x16x32_bf16 v[116:119], a[32:35], a[116:119], v[116:119]
    v_mfma_f32_16x16x32_bf16 v[120:123], a[36:39], a[116:119], v[120:123]
    v_mfma_f32_16x16x32_bf16 v[124:127], a[40:43], a[116:119], v[124:127]
    buffer_load_dwordx4 v204, s[36:39], s71 offen offset:2048 lds
    v_mfma_f32_16x16x32_bf16 v[116:119], a[52:55], a[96:99], v[116:119]
    v_mfma_f32_16x16x32_bf16 v[120:123], a[52:55], a[100:103], v[120:123]
    v_mfma_f32_16x16x32_bf16 v[124:127], a[52:55], a[104:107], v[124:127]
    v_mfma_f32_16x16x32_bf16 v[120:123], a[32:35], a[120:123], v[120:123]
    buffer_load_dwordx4 v205, s[36:39], s71 offen offset:3072 lds
    v_mfma_f32_16x16x32_bf16 v[124:127], a[36:39], a[120:123], v[124:127]
    v_mfma_f32_16x16x32_bf16 v[120:123], a[56:59], a[96:99], v[120:123]
    v_mfma_f32_16x16x32_bf16 v[124:127], a[56:59], a[100:103], v[124:127]
    v_mfma_f32_16x16x32_bf16 v[124:127], a[32:35], a[124:127], v[124:127]
    v_mfma_f32_16x16x32_bf16 v[124:127], a[60:63], a[96:99], v[124:127]
    s_waitcnt lgkmcnt(0)
    s_waitcnt vmcnt(8)
    v_mfma_f32_16x16x32_bf16 v[96:99], a[0:3], a[64:67], v[96:99]
    ds_read_b128 a[96:99], v34 offset:0
    v_mfma_f32_16x16x32_bf16 v[100:103], a[0:3], a[68:71], v[100:103]
    ds_read_b64 a[32:33], v33 offset:3584
    v_mfma_f32_16x16x32_bf16 v[100:103], a[4:7], a[64:67], v[100:103]
    ds_read_b64 a[34:35], v33 offset:3592
    v_mfma_f32_16x16x32_bf16 v[104:107], a[4:7], a[68:71], v[104:107]
    ds_read_b128 a[100:103], v34 offset:512
    v_mfma_f32_16x16x32_bf16 v[104:107], a[0:3], a[72:75], v[104:107]
    ds_read_b64 a[36:37], v33 offset:3072
    v_mfma_f32_16x16x32_bf16 v[108:111], a[4:7], a[72:75], v[108:111]
    ds_read_b64 a[38:39], v33 offset:3080
    v_mfma_f32_16x16x32_bf16 v[104:107], a[8:11], a[64:67], v[104:107]
    ds_read_b128 a[104:107], v34 offset:1024
    v_mfma_f32_16x16x32_bf16 v[108:111], a[8:11], a[68:71], v[108:111]
    ds_read_b64 a[40:41], v33 offset:2560
    v_mfma_f32_16x16x32_bf16 v[112:115], a[8:11], a[72:75], v[112:115]
    ds_read_b64 a[42:43], v33 offset:2568
    v_mfma_f32_16x16x32_bf16 v[108:111], a[0:3], a[76:79], v[108:111]
    ds_read_b128 a[108:111], v34 offset:1536
    v_mfma_f32_16x16x32_bf16 v[112:115], a[4:7], a[76:79], v[112:115]
    ds_read_b64 a[44:45], v33 offset:2048
    v_mfma_f32_16x16x32_bf16 v[116:119], a[8:11], a[76:79], v[116:119]
    ds_read_b64 a[46:47], v33 offset:2056
    v_mfma_f32_16x16x32_bf16 v[108:111], a[12:15], a[64:67], v[108:111]
    ds_read_b128 a[112:115], v34 offset:2048
    v_mfma_f32_16x16x32_bf16 v[112:115], a[12:15], a[68:71], v[112:115]
    ds_read_b64 a[48:49], v33 offset:1536
    v_mfma_f32_16x16x32_bf16 v[116:119], a[12:15], a[72:75], v[116:119]
    ds_read_b64 a[50:51], v33 offset:1544
    v_mfma_f32_16x16x32_bf16 v[120:123], a[12:15], a[76:79], v[120:123]
    ds_read_b128 a[116:119], v34 offset:2560
    v_mfma_f32_16x16x32_bf16 v[112:115], a[0:3], a[80:83], v[112:115]
    ds_read_b64 a[52:53], v33 offset:1024
    v_mfma_f32_16x16x32_bf16 v[116:119], a[4:7], a[80:83], v[116:119]
    ds_read_b64 a[54:55], v33 offset:1032
    v_mfma_f32_16x16x32_bf16 v[120:123], a[8:11], a[80:83], v[120:123]
    ds_read_b128 a[120:123], v34 offset:3072
    v_mfma_f32_16x16x32_bf16 v[124:127], a[12:15], a[80:83], v[124:127]
    ds_read_b64 a[56:57], v33 offset:512
    v_mfma_f32_16x16x32_bf16 v[112:115], a[16:19], a[64:67], v[112:115]
    ds_read_b64 a[58:59], v33 offset:520
    v_mfma_f32_16x16x32_bf16 v[116:119], a[16:19], a[68:71], v[116:119]
    ds_read_b128 a[124:127], v34 offset:3584
    v_mfma_f32_16x16x32_bf16 v[120:123], a[16:19], a[72:75], v[120:123]
    ds_read_b64 a[60:61], v33 offset:0
    v_mfma_f32_16x16x32_bf16 v[124:127], a[16:19], a[76:79], v[124:127]
    ds_read_b64 a[62:63], v33 offset:8
    v_mfma_f32_16x16x32_bf16 v[116:119], a[0:3], a[84:87], v[116:119]
    ds_read_b128 v[144:147], v206 offset:0
    v_mfma_f32_16x16x32_bf16 v[120:123], a[4:7], a[84:87], v[120:123]
    ds_read_b128 v[148:151], v207 offset:0
    v_mfma_f32_16x16x32_bf16 v[124:127], a[8:11], a[84:87], v[124:127]
    ds_read_b128 v[152:155], v206 offset:2048
    v_mfma_f32_16x16x32_bf16 v[116:119], a[20:23], a[64:67], v[116:119]
    ds_read_b128 v[156:159], v207 offset:2048
    v_mfma_f32_16x16x32_bf16 v[120:123], a[20:23], a[68:71], v[120:123]
    ds_read_b128 v[160:163], v206 offset:4096
    v_mfma_f32_16x16x32_bf16 v[124:127], a[20:23], a[72:75], v[124:127]
    ds_read_b128 v[164:167], v207 offset:4096
    v_mfma_f32_16x16x32_bf16 v[120:123], a[0:3], a[88:91], v[120:123]
    ds_read_b128 v[168:171], v206 offset:6144
    v_mfma_f32_16x16x32_bf16 v[124:127], a[4:7], a[88:91], v[124:127]
    ds_read_b128 v[172:175], v207 offset:6144
    v_mfma_f32_16x16x32_bf16 v[120:123], a[24:27], a[64:67], v[120:123]
    ds_read_b128 v[176:179], v206 offset:8192
    v_mfma_f32_16x16x32_bf16 v[124:127], a[24:27], a[68:71], v[124:127]
    ds_read_b128 v[180:183], v207 offset:8192
    v_mfma_f32_16x16x32_bf16 v[124:127], a[0:3], a[92:95], v[124:127]
    ds_read_b128 v[184:187], v206 offset:10240
    ds_read_b128 v[188:191], v207 offset:10240
    v_mfma_f32_16x16x32_bf16 v[124:127], a[28:31], a[64:67], v[124:127]
    ds_read_b128 v[192:195], v206 offset:12288
    ds_read_b128 v[196:199], v207 offset:12288
    s_waitcnt lgkmcnt(0)
    v_mfma_f32_16x16x32_bf16 v[96:99], a[32:35], a[96:99], v[96:99]
    v_mfma_f32_16x16x32_bf16 v[100:103], a[32:35], a[100:103], v[100:103]
    v_mfma_f32_16x16x32_bf16 v[100:103], a[36:39], a[96:99], v[100:103]
    s_add_u32 m0, s70, 0
    s_mov_b32 s71, 229376
    buffer_load_dwordx4 v202, s[36:39], s71 offen offset:0 lds
    v_mfma_f32_16x16x32_bf16 v[104:107], a[36:39], a[100:103], v[104:107]
    v_mfma_f32_16x16x32_bf16 v[104:107], a[32:35], a[104:107], v[104:107]
    v_mfma_f32_16x16x32_bf16 v[108:111], a[36:39], a[104:107], v[108:111]
    v_mfma_f32_16x16x32_bf16 v[104:107], a[40:43], a[96:99], v[104:107]
    buffer_load_dwordx4 v203, s[36:39], s71 offen offset:1024 lds
    v_mfma_f32_16x16x32_bf16 v[108:111], a[40:43], a[100:103], v[108:111]
    v_mfma_f32_16x16x32_bf16 v[112:115], a[40:43], a[104:107], v[112:115]
    v_mfma_f32_16x16x32_bf16 v[108:111], a[32:35], a[108:111], v[108:111]
    v_mfma_f32_16x16x32_bf16 v[112:115], a[36:39], a[108:111], v[112:115]
    buffer_load_dwordx4 v204, s[36:39], s71 offen offset:2048 lds
    v_mfma_f32_16x16x32_bf16 v[116:119], a[40:43], a[108:111], v[116:119]
    v_mfma_f32_16x16x32_bf16 v[108:111], a[44:47], a[96:99], v[108:111]
    v_mfma_f32_16x16x32_bf16 v[112:115], a[44:47], a[100:103], v[112:115]
    v_mfma_f32_16x16x32_bf16 v[116:119], a[44:47], a[104:107], v[116:119]
    buffer_load_dwordx4 v205, s[36:39], s71 offen offset:3072 lds
    v_mfma_f32_16x16x32_bf16 v[120:123], a[44:47], a[108:111], v[120:123]
    v_mfma_f32_16x16x32_bf16 v[112:115], a[32:35], a[112:115], v[112:115]
    v_mfma_f32_16x16x32_bf16 v[116:119], a[36:39], a[112:115], v[116:119]
    v_mfma_f32_16x16x32_bf16 v[120:123], a[40:43], a[112:115], v[120:123]
    s_add_u32 m0, s70, 4096
    s_mov_b32 s71, 344064
    buffer_load_dwordx4 v202, s[36:39], s71 offen offset:0 lds
    v_mfma_f32_16x16x32_bf16 v[124:127], a[44:47], a[112:115], v[124:127]
    v_mfma_f32_16x16x32_bf16 v[112:115], a[48:51], a[96:99], v[112:115]
    v_mfma_f32_16x16x32_bf16 v[116:119], a[48:51], a[100:103], v[116:119]
    v_mfma_f32_16x16x32_bf16 v[120:123], a[48:51], a[104:107], v[120:123]
    buffer_load_dwordx4 v203, s[36:39], s71 offen offset:1024 lds
    v_mfma_f32_16x16x32_bf16 v[124:127], a[48:51], a[108:111], v[124:127]
    v_mfma_f32_16x16x32_bf16 v[116:119], a[32:35], a[116:119], v[116:119]
    v_mfma_f32_16x16x32_bf16 v[120:123], a[36:39], a[116:119], v[120:123]
    v_mfma_f32_16x16x32_bf16 v[124:127], a[40:43], a[116:119], v[124:127]
    buffer_load_dwordx4 v204, s[36:39], s71 offen offset:2048 lds
    v_mfma_f32_16x16x32_bf16 v[116:119], a[52:55], a[96:99], v[116:119]
    v_mfma_f32_16x16x32_bf16 v[120:123], a[52:55], a[100:103], v[120:123]
    v_mfma_f32_16x16x32_bf16 v[124:127], a[52:55], a[104:107], v[124:127]
    v_mfma_f32_16x16x32_bf16 v[120:123], a[32:35], a[120:123], v[120:123]
    buffer_load_dwordx4 v205, s[36:39], s71 offen offset:3072 lds
    v_mfma_f32_16x16x32_bf16 v[124:127], a[36:39], a[120:123], v[124:127]
    v_mfma_f32_16x16x32_bf16 v[120:123], a[56:59], a[96:99], v[120:123]
    v_mfma_f32_16x16x32_bf16 v[124:127], a[56:59], a[100:103], v[124:127]
    v_mfma_f32_16x16x32_bf16 v[124:127], a[32:35], a[124:127], v[124:127]
    v_mfma_f32_16x16x32_bf16 v[124:127], a[60:63], a[96:99], v[124:127]
    s_branch L_convj_22
L_convb_21:
    s_mul_i32 s99, s92, 3
    s_add_u32 s99, s99, s93
    s_sub_u32 s99, s99, 7
    s_mov_b32 s32, s24
    s_mov_b32 s33, s25
    s_mov_b32 s34, 2408448
    s_mov_b32 s35, 0x20000
    s_mov_b32 s36, s22
    s_mov_b32 s37, s23
    s_mov_b32 s38, 896
    s_mov_b32 s39, 0x20000
    s_lshl_b32 s56, s99, 7
    v_and_b32 v238, 7, v0
    v_lshrrev_b32 v237, 3, v0
    v_mul_u32_u24 v237, 5376, v237
    v_lshl_add_u32 v237, v238, 4, v237
    v_add_u32 v237, s56, v237
    v_lshlrev_b32 v238, 2, v0
    ds_read_b128 a[64:67], v34 offset:192
    ds_read_b64 a[0:1], v33 offset:3776
    ds_read_b64 a[2:3], v33 offset:3784
    ds_read_b128 a[68:71], v34 offset:704
    ds_read_b64 a[4:5], v33 offset:3264
    ds_read_b64 a[6:7], v33 offset:3272
    ds_read_b128 a[72:75], v34 offset:1216
    ds_read_b64 a[8:9], v33 offset:2752
    ds_read_b64 a[10:11], v33 offset:2760
    ds_read_b128 a[76:79], v34 offset:1728
    ds_read_b64 a[12:13], v33 offset:2240
    ds_read_b64 a[14:15], v33 offset:2248
    ds_read_b128 a[80:83], v34 offset:2240
    ds_read_b64 a[16:17], v33 offset:1728
    ds_read_b64 a[18:19], v33 offset:1736
    ds_read_b128 a[84:87], v34 offset:2752
    ds_read_b64 a[20:21], v33 offset:1216
    ds_read_b64 a[22:23], v33 offset:1224
    ds_read_b128 a[88:91], v34 offset:3264
    ds_read_b64 a[24:25], v33 offset:704
    ds_read_b64 a[26:27], v33 offset:712
    ds_read_b128 a[92:95], v34 offset:3776
    ds_read_b64 a[28:29], v33 offset:192
    ds_read_b64 a[30:31], v33 offset:200
    s_waitcnt lgkmcnt(0)
    v_mfma_f32_16x16x32_bf16 v[96:99], a[0:3], a[64:67], 0
    ds_read_b128 a[96:99], v34 offset:128
    v_mfma_f32_16x16x32_bf16 v[100:103], a[0:3], a[68:71], 0
    ds_read_b64 a[32:33], v33 offset:3712
    v_mfma_f32_16x16x32_bf16 v[100:103], a[4:7], a[64:67], v[100:103]
    ds_read_b64 a[34:35], v33 offset:3720
    buffer_load_dword a184, v238, s[36:39], 0 offen
    v_mfma_f32_16x16x32_bf16 v[104:107], a[4:7], a[68:71], 0
    ds_read_b128 a[100:103], v34 offset:640
    v_mfma_f32_16x16x32_bf16 v[104:107], a[0:3], a[72:75], v[104:107]
    ds_read_b64 a[36:37], v33 offset:3200
    v_mfma_f32_16x16x32_bf16 v[108:111], a[4:7], a[72:75], 0
    ds_read_b64 a[38:39], v33 offset:3208
    v_mfma_f32_16x16x32_bf16 v[104:107], a[8:11], a[64:67], v[104:107]
    ds_read_b128 a[104:107], v34 offset:1152
    v_mfma_f32_16x16x32_bf16 v[108:111], a[8:11], a[68:71], v[108:111]
    ds_read_b64 a[40:41], v33 offset:2688
    v_mfma_f32_16x16x32_bf16 v[112:115], a[8:11], a[72:75], 0
    ds_read_b64 a[42:43], v33 offset:2696
    v_mfma_f32_16x16x32_bf16 v[108:111], a[0:3], a[76:79], v[108:111]
    ds_read_b128 a[108:111], v34 offset:1664
    v_mfma_f32_16x16x32_bf16 v[112:115], a[4:7], a[76:79], v[112:115]
    ds_read_b64 a[44:45], v33 offset:2176
    s_mov_b32 s71, 0
    buffer_load_dwordx4 a[128:131], v237, s[32:35], s71 offen
    v_mfma_f32_16x16x32_bf16 v[116:119], a[8:11], a[76:79], 0
    ds_read_b64 a[46:47], v33 offset:2184
    v_mfma_f32_16x16x32_bf16 v[108:111], a[12:15], a[64:67], v[108:111]
    ds_read_b128 a[112:115], v34 offset:2176
    v_mfma_f32_16x16x32_bf16 v[112:115], a[12:15], a[68:71], v[112:115]
    ds_read_b64 a[48:49], v33 offset:1664
    v_mfma_f32_16x16x32_bf16 v[116:119], a[12:15], a[72:75], v[116:119]
    ds_read_b64 a[50:51], v33 offset:1672
    v_mfma_f32_16x16x32_bf16 v[120:123], a[12:15], a[76:79], 0
    ds_read_b128 a[116:119], v34 offset:2688
    v_mfma_f32_16x16x32_bf16 v[112:115], a[0:3], a[80:83], v[112:115]
    ds_read_b64 a[52:53], v33 offset:1152
    v_mfma_f32_16x16x32_bf16 v[116:119], a[4:7], a[80:83], v[116:119]
    ds_read_b64 a[54:55], v33 offset:1160
    v_mfma_f32_16x16x32_bf16 v[120:123], a[8:11], a[80:83], v[120:123]
    ds_read_b128 a[120:123], v34 offset:3200
    s_mov_b32 s71, 172032
    buffer_load_dwordx4 a[132:135], v237, s[32:35], s71 offen
    v_mfma_f32_16x16x32_bf16 v[124:127], a[12:15], a[80:83], 0
    ds_read_b64 a[56:57], v33 offset:640
    v_mfma_f32_16x16x32_bf16 v[112:115], a[16:19], a[64:67], v[112:115]
    ds_read_b64 a[58:59], v33 offset:648
    v_mfma_f32_16x16x32_bf16 v[116:119], a[16:19], a[68:71], v[116:119]
    ds_read_b128 a[124:127], v34 offset:3712
    v_mfma_f32_16x16x32_bf16 v[120:123], a[16:19], a[72:75], v[120:123]
    ds_read_b64 a[60:61], v33 offset:128
    v_mfma_f32_16x16x32_bf16 v[124:127], a[16:19], a[76:79], v[124:127]
    ds_read_b64 a[62:63], v33 offset:136
    v_mfma_f32_16x16x32_bf16 v[116:119], a[0:3], a[84:87], v[116:119]
    v_mfma_f32_16x16x32_bf16 v[120:123], a[4:7], a[84:87], v[120:123]
    v_mfma_f32_16x16x32_bf16 v[124:127], a[8:11], a[84:87], v[124:127]
    s_mov_b32 s71, 344064
    buffer_load_dwordx4 a[136:139], v237, s[32:35], s71 offen
    v_mfma_f32_16x16x32_bf16 v[116:119], a[20:23], a[64:67], v[116:119]
    v_mfma_f32_16x16x32_bf16 v[120:123], a[20:23], a[68:71], v[120:123]
    v_mfma_f32_16x16x32_bf16 v[124:127], a[20:23], a[72:75], v[124:127]
    v_mfma_f32_16x16x32_bf16 v[120:123], a[0:3], a[88:91], v[120:123]
    v_mfma_f32_16x16x32_bf16 v[124:127], a[4:7], a[88:91], v[124:127]
    v_mfma_f32_16x16x32_bf16 v[120:123], a[24:27], a[64:67], v[120:123]
    v_mfma_f32_16x16x32_bf16 v[124:127], a[24:27], a[68:71], v[124:127]
    v_mfma_f32_16x16x32_bf16 v[124:127], a[0:3], a[92:95], v[124:127]
    v_mfma_f32_16x16x32_bf16 v[124:127], a[28:31], a[64:67], v[124:127]
    s_waitcnt lgkmcnt(0)
    v_mfma_f32_16x16x32_bf16 v[96:99], a[32:35], a[96:99], v[96:99]
    ds_read_b128 a[64:67], v34 offset:64
    v_mfma_f32_16x16x32_bf16 v[100:103], a[32:35], a[100:103], v[100:103]
    ds_read_b64 a[0:1], v33 offset:3648
    v_mfma_f32_16x16x32_bf16 v[100:103], a[36:39], a[96:99], v[100:103]
    ds_read_b64 a[2:3], v33 offset:3656
    s_mov_b32 s71, 516096
    buffer_load_dwordx4 a[140:143], v237, s[32:35], s71 offen
    v_mfma_f32_16x16x32_bf16 v[104:107], a[36:39], a[100:103], v[104:107]
    ds_read_b128 a[68:71], v34 offset:576
    v_mfma_f32_16x16x32_bf16 v[104:107], a[32:35], a[104:107], v[104:107]
    ds_read_b64 a[4:5], v33 offset:3136
    v_mfma_f32_16x16x32_bf16 v[108:111], a[36:39], a[104:107], v[108:111]
    ds_read_b64 a[6:7], v33 offset:3144
    v_mfma_f32_16x16x32_bf16 v[104:107], a[40:43], a[96:99], v[104:107]
    ds_read_b128 a[72:75], v34 offset:1088
    v_mfma_f32_16x16x32_bf16 v[108:111], a[40:43], a[100:103], v[108:111]
    ds_read_b64 a[8:9], v33 offset:2624
    v_mfma_f32_16x16x32_bf16 v[112:115], a[40:43], a[104:107], v[112:115]
    ds_read_b64 a[10:11], v33 offset:2632
    v_mfma_f32_16x16x32_bf16 v[108:111], a[32:35], a[108:111], v[108:111]
    ds_read_b128 a[76:79], v34 offset:1600
    v_mfma_f32_16x16x32_bf16 v[112:115], a[36:39], a[108:111], v[112:115]
    ds_read_b64 a[12:13], v33 offset:2112
    s_mov_b32 s71, 688128
    buffer_load_dwordx4 a[144:147], v237, s[32:35], s71 offen
    v_mfma_f32_16x16x32_bf16 v[116:119], a[40:43], a[108:111], v[116:119]
    ds_read_b64 a[14:15], v33 offset:2120
    v_mfma_f32_16x16x32_bf16 v[108:111], a[44:47], a[96:99], v[108:111]
    ds_read_b128 a[80:83], v34 offset:2112
    v_mfma_f32_16x16x32_bf16 v[112:115], a[44:47], a[100:103], v[112:115]
    ds_read_b64 a[16:17], v33 offset:1600
    v_mfma_f32_16x16x32_bf16 v[116:119], a[44:47], a[104:107], v[116:119]
    ds_read_b64 a[18:19], v33 offset:1608
    v_mfma_f32_16x16x32_bf16 v[120:123], a[44:47], a[108:111], v[120:123]
    ds_read_b128 a[84:87], v34 offset:2624
    v_mfma_f32_16x16x32_bf16 v[112:115], a[32:35], a[112:115], v[112:115]
    ds_read_b64 a[20:21], v33 offset:1088
    v_mfma_f32_16x16x32_bf16 v[116:119], a[36:39], a[112:115], v[116:119]
    ds_read_b64 a[22:23], v33 offset:1096
    v_mfma_f32_16x16x32_bf16 v[120:123], a[40:43], a[112:115], v[120:123]
    ds_read_b128 a[88:91], v34 offset:3136
    s_mov_b32 s71, 860160
    buffer_load_dwordx4 a[148:151], v237, s[32:35], s71 offen
    v_mfma_f32_16x16x32_bf16 v[124:127], a[44:47], a[112:115], v[124:127]
    ds_read_b64 a[24:25], v33 offset:576
    v_mfma_f32_16x16x32_bf16 v[112:115], a[48:51], a[96:99], v[112:115]
    ds_read_b64 a[26:27], v33 offset:584
    v_mfma_f32_16x16x32_bf16 v[116:119], a[48:51], a[100:103], v[116:119]
    ds_read_b128 a[92:95], v34 offset:3648
    v_mfma_f32_16x16x32_bf16 v[120:123], a[48:51], a[104:107], v[120:123]
    ds_read_b64 a[28:29], v33 offset:64
    v_mfma_f32_16x16x32_bf16 v[124:127], a[48:51], a[108:111], v[124:127]
    ds_read_b64 a[30:31], v33 offset:72
    v_mfma_f32_16x16x32_bf16 v[116:119], a[32:35], a[116:119], v[116:119]
    v_mfma_f32_16x16x32_bf16 v[120:123], a[36:39], a[116:119], v[120:123]
    v_mfma_f32_16x16x32_bf16 v[124:127], a[40:43], a[116:119], v[124:127]
    s_mov_b32 s71, 1032192
    buffer_load_dwordx4 a[152:155], v237, s[32:35], s71 offen
    v_mfma_f32_16x16x32_bf16 v[116:119], a[52:55], a[96:99], v[116:119]
    v_mfma_f32_16x16x32_bf16 v[120:123], a[52:55], a[100:103], v[120:123]
    v_mfma_f32_16x16x32_bf16 v[124:127], a[52:55], a[104:107], v[124:127]
    v_mfma_f32_16x16x32_bf16 v[120:123], a[32:35], a[120:123], v[120:123]
    v_mfma_f32_16x16x32_bf16 v[124:127], a[36:39], a[120:123], v[124:127]
    v_mfma_f32_16x16x32_bf16 v[120:123], a[56:59], a[96:99], v[120:123]
    v_mfma_f32_16x16x32_bf16 v[124:127], a[56:59], a[100:103], v[124:127]
    v_mfma_f32_16x16x32_bf16 v[124:127], a[32:35], a[124:127], v[124:127]
    v_mfma_f32_16x16x32_bf16 v[124:127], a[60:63], a[96:99], v[124:127]
    s_waitcnt lgkmcnt(0)
    v_mfma_f32_16x16x32_bf16 v[96:99], a[0:3], a[64:67], v[96:99]
    ds_read_b128 a[96:99], v34 offset:0
    v_mfma_f32_16x16x32_bf16 v[100:103], a[0:3], a[68:71], v[100:103]
    ds_read_b64 a[32:33], v33 offset:3584
    v_mfma_f32_16x16x32_bf16 v[100:103], a[4:7], a[64:67], v[100:103]
    ds_read_b64 a[34:35], v33 offset:3592
    s_mov_b32 s71, 1204224
    buffer_load_dwordx4 a[156:159], v237, s[32:35], s71 offen
    v_mfma_f32_16x16x32_bf16 v[104:107], a[4:7], a[68:71], v[104:107]
    ds_read_b128 a[100:103], v34 offset:512
    v_mfma_f32_16x16x32_bf16 v[104:107], a[0:3], a[72:75], v[104:107]
    ds_read_b64 a[36:37], v33 offset:3072
    v_mfma_f32_16x16x32_bf16 v[108:111], a[4:7], a[72:75], v[108:111]
    ds_read_b64 a[38:39], v33 offset:3080
    v_mfma_f32_16x16x32_bf16 v[104:107], a[8:11], a[64:67], v[104:107]
    ds_read_b128 a[104:107], v34 offset:1024
    v_mfma_f32_16x16x32_bf16 v[108:111], a[8:11], a[68:71], v[108:111]
    ds_read_b64 a[40:41], v33 offset:2560
    v_mfma_f32_16x16x32_bf16 v[112:115], a[8:11], a[72:75], v[112:115]
    ds_read_b64 a[42:43], v33 offset:2568
    v_mfma_f32_16x16x32_bf16 v[108:111], a[0:3], a[76:79], v[108:111]
    ds_read_b128 a[108:111], v34 offset:1536
    v_mfma_f32_16x16x32_bf16 v[112:115], a[4:7], a[76:79], v[112:115]
    ds_read_b64 a[44:45], v33 offset:2048
    s_mov_b32 s71, 1376256
    buffer_load_dwordx4 a[160:163], v237, s[32:35], s71 offen
    v_mfma_f32_16x16x32_bf16 v[116:119], a[8:11], a[76:79], v[116:119]
    ds_read_b64 a[46:47], v33 offset:2056
    v_mfma_f32_16x16x32_bf16 v[108:111], a[12:15], a[64:67], v[108:111]
    ds_read_b128 a[112:115], v34 offset:2048
    v_mfma_f32_16x16x32_bf16 v[112:115], a[12:15], a[68:71], v[112:115]
    ds_read_b64 a[48:49], v33 offset:1536
    v_mfma_f32_16x16x32_bf16 v[116:119], a[12:15], a[72:75], v[116:119]
    ds_read_b64 a[50:51], v33 offset:1544
    v_mfma_f32_16x16x32_bf16 v[120:123], a[12:15], a[76:79], v[120:123]
    ds_read_b128 a[116:119], v34 offset:2560
    v_mfma_f32_16x16x32_bf16 v[112:115], a[0:3], a[80:83], v[112:115]
    ds_read_b64 a[52:53], v33 offset:1024
    v_mfma_f32_16x16x32_bf16 v[116:119], a[4:7], a[80:83], v[116:119]
    ds_read_b64 a[54:55], v33 offset:1032
    v_mfma_f32_16x16x32_bf16 v[120:123], a[8:11], a[80:83], v[120:123]
    ds_read_b128 a[120:123], v34 offset:3072
    s_mov_b32 s71, 1548288
    buffer_load_dwordx4 a[164:167], v237, s[32:35], s71 offen
    v_mfma_f32_16x16x32_bf16 v[124:127], a[12:15], a[80:83], v[124:127]
    ds_read_b64 a[56:57], v33 offset:512
    v_mfma_f32_16x16x32_bf16 v[112:115], a[16:19], a[64:67], v[112:115]
    ds_read_b64 a[58:59], v33 offset:520
    v_mfma_f32_16x16x32_bf16 v[116:119], a[16:19], a[68:71], v[116:119]
    ds_read_b128 a[124:127], v34 offset:3584
    v_mfma_f32_16x16x32_bf16 v[120:123], a[16:19], a[72:75], v[120:123]
    ds_read_b64 a[60:61], v33 offset:0
    v_mfma_f32_16x16x32_bf16 v[124:127], a[16:19], a[76:79], v[124:127]
    ds_read_b64 a[62:63], v33 offset:8
    v_mfma_f32_16x16x32_bf16 v[116:119], a[0:3], a[84:87], v[116:119]
    v_mfma_f32_16x16x32_bf16 v[120:123], a[4:7], a[84:87], v[120:123]
    v_mfma_f32_16x16x32_bf16 v[124:127], a[8:11], a[84:87], v[124:127]
    s_mov_b32 s71, 1720320
    buffer_load_dwordx4 a[168:171], v237, s[32:35], s71 offen
    v_mfma_f32_16x16x32_bf16 v[116:119], a[20:23], a[64:67], v[116:119]
    v_mfma_f32_16x16x32_bf16 v[120:123], a[20:23], a[68:71], v[120:123]
    v_mfma_f32_16x16x32_bf16 v[124:127], a[20:23], a[72:75], v[124:127]
    v_mfma_f32_16x16x32_bf16 v[120:123], a[0:3], a[88:91], v[120:123]
    v_mfma_f32_16x16x32_bf16 v[124:127], a[4:7], a[88:91], v[124:127]
    v_mfma_f32_16x16x32_bf16 v[120:123], a[24:27], a[64:67], v[120:123]
    v_mfma_f32_16x16x32_bf16 v[124:127], a[24:27], a[68:71], v[124:127]
    v_mfma_f32_16x16x32_bf16 v[124:127], a[0:3], a[92:95], v[124:127]
    v_mfma_f32_16x16x32_bf16 v[124:127], a[28:31], a[64:67], v[124:127]
    s_waitcnt lgkmcnt(0)
    v_mfma_f32_16x16x32_bf16 v[96:99], a[32:35], a[96:99], v[96:99]
    v_mfma_f32_16x16x32_bf16 v[100:103], a[32:35], a[100:103], v[100:103]
    v_mfma_f32_16x16x32_bf16 v[100:103], a[36:39], a[96:99], v[100:103]
    s_mov_b32 s71, 1892352
    buffer_load_dwordx4 a[172:175], v237, s[32:35], s71 offen
    v_mfma_f32_16x16x32_bf16 v[104:107], a[36:39], a[100:103], v[104:107]
    v_mfma_f32_16x16x32_bf16 v[104:107], a[32:35], a[104:107], v[104:107]
    v_mfma_f32_16x16x32_bf16 v[108:111], a[36:39], a[104:107], v[108:111]
    v_mfma_f32_16x16x32_bf16 v[104:107], a[40:43], a[96:99], v[104:107]
    v_mfma_f32_16x16x32_bf16 v[108:111], a[40:43], a[100:103], v[108:111]
    v_mfma_f32_16x16x32_bf16 v[112:115], a[40:43], a[104:107], v[112:115]
    v_mfma_f32_16x16x32_bf16 v[108:111], a[32:35], a[108:111], v[108:111]
    v_mfma_f32_16x16x32_bf16 v[112:115], a[36:39], a[108:111], v[112:115]
    s_mov_b32 s71, 2064384
    buffer_load_dwordx4 a[176:179], v237, s[32:35], s71 offen
    v_mfma_f32_16x16x32_bf16 v[116:119], a[40:43], a[108:111], v[116:119]
    v_mfma_f32_16x16x32_bf16 v[108:111], a[44:47], a[96:99], v[108:111]
    v_mfma_f32_16x16x32_bf16 v[112:115], a[44:47], a[100:103], v[112:115]
    v_mfma_f32_16x16x32_bf16 v[116:119], a[44:47], a[104:107], v[116:119]
    v_mfma_f32_16x16x32_bf16 v[120:123], a[44:47], a[108:111], v[120:123]
    v_mfma_f32_16x16x32_bf16 v[112:115], a[32:35], a[112:115], v[112:115]
    v_mfma_f32_16x16x32_bf16 v[116:119], a[36:39], a[112:115], v[116:119]
    v_mfma_f32_16x16x32_bf16 v[120:123], a[40:43], a[112:115], v[120:123]
    s_mov_b32 s71, 2236416
    buffer_load_dwordx4 a[180:183], v237, s[32:35], s71 offen
    v_mfma_f32_16x16x32_bf16 v[124:127], a[44:47], a[112:115], v[124:127]
    v_mfma_f32_16x16x32_bf16 v[112:115], a[48:51], a[96:99], v[112:115]
    v_mfma_f32_16x16x32_bf16 v[116:119], a[48:51], a[100:103], v[116:119]
    v_mfma_f32_16x16x32_bf16 v[120:123], a[48:51], a[104:107], v[120:123]
    v_mfma_f32_16x16x32_bf16 v[124:127], a[48:51], a[108:111], v[124:127]
    v_mfma_f32_16x16x32_bf16 v[116:119], a[32:35], a[116:119], v[116:119]
    v_mfma_f32_16x16x32_bf16 v[120:123], a[36:39], a[116:119], v[120:123]
    v_mfma_f32_16x16x32_bf16 v[124:127], a[40:43], a[116:119], v[124:127]
    v_mfma_f32_16x16x32_bf16 v[116:119], a[52:55], a[96:99], v[116:119]
    v_mfma_f32_16x16x32_bf16 v[120:123], a[52:55], a[100:103], v[120:123]
    v_mfma_f32_16x16x32_bf16 v[124:127], a[52:55], a[104:107], v[124:127]
    v_mfma_f32_16x16x32_bf16 v[120:123], a[32:35], a[120:123], v[120:123]
    v_mfma_f32_16x16x32_bf16 v[124:127], a[36:39], a[120:123], v[124:127]
    v_mfma_f32_16x16x32_bf16 v[120:123], a[56:59], a[96:99], v[120:123]
    v_mfma_f32_16x16x32_bf16 v[124:127], a[56:59], a[100:103], v[124:127]
    v_mfma_f32_16x16x32_bf16 v[124:127], a[32:35], a[124:127], v[124:127]
    v_mfma_f32_16x16x32_bf16 v[124:127], a[60:63], a[96:99], v[124:127]
L_convj_22:
    v_min_u32 v245, 20, v1
    v_lshlrev_b32 v245, 6, v245
    v_add_u32 v245, 36864, v245
    s_cmp_lg_u32 s91, 0
    s_cbranch_scc1 L_w0_23
    buffer_load_dwordx2 v[246:247], v245, s[52:55], 0 offen sc1
L_w0_23:
    s_lshl_b32 s56, s91, 12
    s_add_u32 s56, s56, 42496
    v_add_u32 v35, s56, v9
    s_xor_b32 s57, s91, 1
    s_lshl_b32 s57, s57, 12
    s_add_u32 s57, s57, 42496
    v_add_u32 v36, s57, v9
    v_lshlrev_b32 v10, 5, v2
    v_lshl_add_u32 v10, v3, 3, v10
    s_add_u32 s56, s66, s68
    s_add_u32 s56, s56, 480
    v_add_u32 v37, s56, v10
    ds_read_b64 v[40:41], v37 offset:0
    ds_read_b64 v[42:43], v37 offset:512
    ds_read_b64 v[44:45], v37 offset:1024
    ds_read_b64 v[46:47], v37 offset:1536
    v_and_b32 v11, 1, v3
    v_lshlrev_b32 v11, 9, v11
    v_lshl_add_u32 v11, v2, 5, v11
    v_lshrrev_b32 v12, 1, v3
    v_lshl_add_u32 v11, v12, 4, v11
    v_lshlrev_b32 v140, 16, v140
    s_cmp_eq_u32 s61, 1
    s_cbranch_scc1 L_h1_24
    ds_write_b128 v35, v[112:115] offset:0
    ds_write_b128 v35, v[116:119] offset:1024
    ds_write_b128 v35, v[120:123] offset:2048
    ds_write_b128 v35, v[124:127] offset:3072
    s_branch L_join_25
L_h1_24:
    ds_write_b128 v35, v[96:99] offset:0
    ds_write_b128 v35, v[100:103] offset:1024
    ds_write_b128 v35, v[104:107] offset:2048
    ds_write_b128 v35, v[108:111] offset:3072
    v_mov_b32 v96, v112
    v_mov_b32 v97, v113
    v_mov_b32 v98, v114
    v_mov_b32 v99, v115
    v_mov_b32 v100, v116
    v_mov_b32 v101, v117
    v_mov_b32 v102, v118
    v_mov_b32 v103, v119
    v_mov_b32 v104, v120
    v_mov_b32 v105, v121
    v_mov_b32 v106, v122
    v_mov_b32 v107, v123
    v_mov_b32 v108, v124
    v_mov_b32 v109, v125
    v_mov_b32 v110, v126
    v_mov_b32 v111, v127
L_join_25:
    s_waitcnt lgkmcnt(4)
    v_lshlrev_b32 v64, 16, v40
    v_and_b32 v65, s90, v40
    v_pk_fma_f32 v[96:97], v[64:65], v[140:141], v[96:97] op_sel_hi:[1,0,1]
    s_add_u32 m0, s70, 8192
    s_mov_b32 s71, 458752
    buffer_load_dwordx4 v202, s[36:39], s71 offen offset:0 lds
    v_lshlrev_b32 v66, 16, v41
    v_and_b32 v67, s90, v41
    v_pk_fma_f32 v[98:99], v[66:67], v[140:141], v[98:99] op_sel_hi:[1,0,1]
    buffer_load_dwordx4 v203, s[36:39], s71 offen offset:1024 lds
    v_lshlrev_b32 v64, 16, v42
    v_and_b32 v65, s90, v42
    v_pk_fma_f32 v[100:101], v[64:65], v[140:141], v[100:101] op_sel_hi:[1,0,1]
    buffer_load_dwordx4 v204, s[36:39], s71 offen offset:2048 lds
    v_lshlrev_b32 v66, 16, v43
    v_and_b32 v67, s90, v43
    v_pk_fma_f32 v[102:103], v[66:67], v[140:141], v[102:103] op_sel_hi:[1,0,1]
    buffer_load_dwordx4 v205, s[36:39], s71 offen offset:3072 lds
    v_lshlrev_b32 v64, 16, v44
    v_and_b32 v65, s90, v44
    v_pk_fma_f32 v[104:105], v[64:65], v[140:141], v[104:105] op_sel_hi:[1,0,1]
    s_add_u32 m0, s70, 12288
    s_mov_b32 s71, 573440
    buffer_load_dwordx4 v202, s[36:39], s71 offen offset:0 lds
    v_lshlrev_b32 v66, 16, v45
    v_and_b32 v67, s90, v45
    v_pk_fma_f32 v[106:107], v[66:67], v[140:141], v[106:107] op_sel_hi:[1,0,1]
    buffer_load_dwordx4 v203, s[36:39], s71 offen offset:1024 lds
    v_lshlrev_b32 v64, 16, v46
    v_and_b32 v65, s90, v46
    v_pk_fma_f32 v[108:109], v[64:65], v[140:141], v[108:109] op_sel_hi:[1,0,1]
    buffer_load_dwordx4 v204, s[36:39], s71 offen offset:2048 lds
    v_lshlrev_b32 v66, 16, v47
    v_and_b32 v67, s90, v47
    v_pk_fma_f32 v[110:111], v[66:67], v[140:141], v[110:111] op_sel_hi:[1,0,1]
    buffer_load_dwordx4 v205, s[36:39], s71 offen offset:3072 lds
    s_waitcnt lgkmcnt(0)
    s_barrier
    ds_read_b128 v[48:51], v36 offset:0
    ds_read_b128 v[52:55], v36 offset:1024
    ds_read_b128 v[56:59], v36 offset:2048
    ds_read_b128 v[60:63], v36 offset:3072
    s_waitcnt lgkmcnt(3)
    v_pk_add_f32 v[96:97], v[96:97], v[48:49]
    v_cvt_pk_bf16_f32 v72, v96, v97
    v_pk_add_f32 v[98:99], v[98:99], v[50:51]
    v_cvt_pk_bf16_f32 v73, v98, v99
    s_waitcnt lgkmcnt(2)
    v_pk_add_f32 v[100:101], v[100:101], v[52:53]
    v_cvt_pk_bf16_f32 v74, v100, v101
    v_pk_add_f32 v[102:103], v[102:103], v[54:55]
    v_cvt_pk_bf16_f32 v75, v102, v103
    v_permlane16_swap_b32 v72, v74
    s_nop 0
    v_permlane16_swap_b32 v73, v75
    buffer_store_dwordx4 v[72:75], v11, s[44:47], s69 offen offset:0 sc1
    s_waitcnt lgkmcnt(1)
    v_pk_add_f32 v[104:105], v[104:105], v[56:57]
    v_cvt_pk_bf16_f32 v76, v104, v105
    v_pk_add_f32 v[106:107], v[106:107], v[58:59]
    v_cvt_pk_bf16_f32 v77, v106, v107
    s_waitcnt lgkmcnt(0)
    v_pk_add_f32 v[108:109], v[108:109], v[60:61]
    v_cvt_pk_bf16_f32 v78, v108, v109
    v_pk_add_f32 v[110:111], v[110:111], v[62:63]
    v_cvt_pk_bf16_f32 v79, v110, v111
    v_permlane16_swap_b32 v76, v78
    s_nop 0
    v_permlane16_swap_b32 v77, v79
    buffer_store_dwordx4 v[76:79], v11, s[44:47], s69 offen offset:1024 sc1
    s_cmp_ge_u32 s93, 28
    s_cbranch_scc1 L_nostat_26
    s_waitcnt vmcnt(14)
    v_lshrrev_b32 v22, 2, v2
    v_lshl_add_u32 v12, v3, 3, v22
    v_lshrrev_b32 v22, 1, v22
    v_and_b32 v23, 1, v3
    v_lshl_or_b32 v22, v23, 1, v22
    v_xor_b32 v22, 0, v22
    v_lshlrev_b32 v22, 5, v22
    v_lshl_add_u32 v12, v12, 7, v22
    v_and_b32 v22, 3, v2
    v_lshl_add_u32 v12, v22, 3, v12
    v_add_u32 v12, s70, v12
    v_lshrrev_b32 v22, 2, v2
    v_lshl_add_u32 v13, v3, 3, v22
    v_lshrrev_b32 v22, 1, v22
    v_and_b32 v23, 1, v3
    v_lshl_or_b32 v22, v23, 1, v22
    v_xor_b32 v22, 1, v22
    v_lshlrev_b32 v22, 5, v22
    v_lshl_add_u32 v13, v13, 7, v22
    v_and_b32 v22, 3, v2
    v_lshl_add_u32 v13, v22, 3, v13
    v_add_u32 v13, s70, v13
    v_lshrrev_b32 v22, 2, v2
    v_lshl_add_u32 v14, v3, 3, v22
    v_lshrrev_b32 v22, 1, v22
    v_and_b32 v23, 1, v3
    v_lshl_or_b32 v22, v23, 1, v22
    v_xor_b32 v22, 2, v22
    v_lshlrev_b32 v22, 5, v22
    v_lshl_add_u32 v14, v14, 7, v22
    v_and_b32 v22, 3, v2
    v_lshl_add_u32 v14, v22, 3, v14
    v_add_u32 v14, s70, v14
    v_lshrrev_b32 v22, 2, v2
    v_lshl_add_u32 v15, v3, 3, v22
    v_lshrrev_b32 v22, 1, v22
    v_and_b32 v23, 1, v3
    v_lshl_or_b32 v22, v23, 1, v22
    v_xor_b32 v22, 3, v22
    v_lshlrev_b32 v22, 5, v22
    v_lshl_add_u32 v15, v15, 7, v22
    v_and_b32 v22, 3, v2
    v_lshl_add_u32 v15, v22, 3, v15
    v_add_u32 v15, s70, v15
    v_mov_b32 v16, 0x3f803f80
    v_mov_b32 v17, v16
    v_mov_b32 v18, v16
    v_mov_b32 v19, v16
    v_and_b32 v20, 3, v0
    v_cmp_eq_u32 s[64:65], 1, v20
    v_cmp_eq_u32 s[66:67], 2, v20
    v_cmp_eq_u32 s[68:69], 3, v20
    v_lshrrev_b32 v20, 2, v2
    v_lshl_add_u32 v20, v20, 4, v2
    v_lshlrev_b32 v20, 2, v20
    v_mfma_f32_16x16x32_bf16 v[24:27], v[16:19], v[144:147], 0
    ds_read_b64_tr_b16 a[0:1], v12 offset:16384
    v_mfma_f32_16x16x32_bf16 v[28:31], v[144:147], v[144:147], 0
    ds_read_b64_tr_b16 a[2:3], v12 offset:16896
    v_mfma_f32_16x16x32_bf16 v[24:27], v[16:19], v[148:151], v[24:27]
    ds_read_b64_tr_b16 a[4:5], v13 offset:16384
    v_mfma_f32_16x16x32_bf16 v[28:31], v[148:151], v[148:151], v[28:31]
    ds_read_b64_tr_b16 a[6:7], v13 offset:16896
    v_mfma_f32_16x16x32_bf16 v[24:27], v[16:19], v[152:155], v[24:27]
    ds_read_b64_tr_b16 a[8:9], v14 offset:16384
    v_mfma_f32_16x16x32_bf16 v[28:31], v[152:155], v[152:155], v[28:31]
    ds_read_b64_tr_b16 a[10:11], v14 offset:16896
    v_mfma_f32_16x16x32_bf16 v[24:27], v[16:19], v[156:159], v[24:27]
    ds_read_b64_tr_b16 a[12:13], v15 offset:16384
    v_mfma_f32_16x16x32_bf16 v[28:31], v[156:159], v[156:159], v[28:31]
    ds_read_b64_tr_b16 a[14:15], v15 offset:16896
    v_mfma_f32_16x16x32_bf16 v[24:27], v[16:19], v[160:163], v[24:27]
    ds_read_b64_tr_b16 a[16:17], v12 offset:20480
    v_mfma_f32_16x16x32_bf16 v[28:31], v[160:163], v[160:163], v[28:31]
    ds_read_b64_tr_b16 a[18:19], v12 offset:20992
    v_mfma_f32_16x16x32_bf16 v[24:27], v[16:19], v[164:167], v[24:27]
    ds_read_b64_tr_b16 a[20:21], v13 offset:20480
    v_mfma_f32_16x16x32_bf16 v[28:31], v[164:167], v[164:167], v[28:31]
    ds_read_b64_tr_b16 a[22:23], v13 offset:20992
    v_mfma_f32_16x16x32_bf16 v[24:27], v[16:19], v[168:171], v[24:27]
    ds_read_b64_tr_b16 a[24:25], v14 offset:20480
    v_mfma_f32_16x16x32_bf16 v[28:31], v[168:171], v[168:171], v[28:31]
    ds_read_b64_tr_b16 a[26:27], v14 offset:20992
    v_mfma_f32_16x16x32_bf16 v[24:27], v[16:19], v[172:175], v[24:27]
    ds_read_b64_tr_b16 a[28:29], v15 offset:20480
    v_mfma_f32_16x16x32_bf16 v[28:31], v[172:175], v[172:175], v[28:31]
    ds_read_b64_tr_b16 a[30:31], v15 offset:20992
    v_mfma_f32_16x16x32_bf16 v[24:27], v[16:19], v[176:179], v[24:27]
    ds_read_b64_tr_b16 a[32:33], v12 offset:0
    v_mfma_f32_16x16x32_bf16 v[28:31], v[176:179], v[176:179], v[28:31]
    ds_read_b64_tr_b16 a[34:35], v12 offset:512
    v_mfma_f32_16x16x32_bf16 v[24:27], v[16:19], v[180:183], v[24:27]
    ds_read_b64_tr_b16 a[36:37], v13 offset:0
    v_mfma_f32_16x16x32_bf16 v[28:31], v[180:183], v[180:183], v[28:31]
    ds_read_b64_tr_b16 a[38:39], v13 offset:512
    v_mfma_f32_16x16x32_bf16 v[24:27], v[16:19], v[184:187], v[24:27]
    ds_read_b64_tr_b16 a[40:41], v14 offset:0
    v_mfma_f32_16x16x32_bf16 v[28:31], v[184:187], v[184:187], v[28:31]
    ds_read_b64_tr_b16 a[42:43], v14 offset:512
    v_mfma_f32_16x16x32_bf16 v[24:27], v[16:19], v[188:191], v[24:27]
    ds_read_b64_tr_b16 a[44:45], v15 offset:0
    v_mfma_f32_16x16x32_bf16 v[28:31], v[188:191], v[188:191], v[28:31]
    ds_read_b64_tr_b16 a[46:47], v15 offset:512
    v_mfma_f32_16x16x32_bf16 v[24:27], v[16:19], v[192:195], v[24:27]
    v_mfma_f32_16x16x32_bf16 v[28:31], v[192:195], v[192:195], v[28:31]
    v_mfma_f32_16x16x32_bf16 v[24:27], v[16:19], v[196:199], v[24:27]
    v_mfma_f32_16x16x32_bf16 v[28:31], v[196:199], v[196:199], v[28:31]
    s_nop 7
    v_cndmask_b32 v28, v28, v29, s[64:65]
    s_nop 6
    v_cndmask_b32 v28, v28, v30, s[66:67]
    s_nop 5
    v_cndmask_b32 v28, v28, v31, s[68:69]
    s_nop 4
    ds_bpermute_b32 v29, v20, v28
    s_waitcnt lgkmcnt(0)
    s_waitcnt lgkmcnt(0)
    s_nop 0
    v_mov_b32 v8, v24
    s_nop 0
    v_mov_b32 v10, v29
    v_mul_f32 v8, 0x3b124925, v8
    v_mul_f32 v10, 0x3b124925, v10
    v_fma_f32 v10, -v8, v8, v10
    v_max_f32 v10, 0, v10
    v_add_f32 v10, 0x3727c5ac, v10
    v_rsq_f32 v10, v10
    s_nop 0
    v_mul_f32_e64 v6, -v8, v10
L_nostat_26:
    s_waitcnt vmcnt(0)
    s_barrier
    s_lshl_b32 s57, s92, 5
    s_add_u32 s57, s57, s93
    s_lshl_b32 s57, s57, 6
    s_cmp_lg_u32 s91, 0
    s_cbranch_scc1 L_w0_27
    s_add_u32 s56, s57, 40960
    v_mov_b32 v250, s56
    v_mov_b32 v252, s88
    v_mov_b32 v253, s89
    s_mov_b64 exec, 1
    buffer_store_dwordx2 v[252:253], v250, s[52:55], 0 offen sc1
    s_mov_b64 exec, -1
L_w0_27:
    s_lshl_b32 s56, s92, 5
    s_add_u32 s56, s56, s93
    s_mul_i32 s59, s56, 7168
    v_min_u32 v248, 55, v1
    v_lshlrev_b32 v248, 7, v248
    s_mov_b32 s48, s20
    s_mov_b32 s49, s21
    s_mov_b32 s50, 1605632
    s_mov_b32 s51, 0x20000
    s_cmp_eq_u32 s91, 3
    s_cbranch_scc0 L_wtd_28
    buffer_load_dword v255, v248, s[48:51], s59 offen
L_wtd_28:
    s_cmp_ge_u32 s93, 28
    s_cbranch_scc1 L_nomlp
    s_branch L_win2
L_nomlp:
    s_cmp_eq_u32 s93, 31
    s_cbranch_scc1 L_nomod2_29
    v_accvgpr_read_b32 v8, a184
    v_lshlrev_b32 v10, 16, v8
    v_and_b32 v11, s90, v8
    v_mul_f32 v12, 0xbfb8aa3b, v10
    v_mul_f32 v13, 0xbfb8aa3b, v11
    v_exp_f32 v12, v12
    v_exp_f32 v13, v13
    v_add_f32 v12, 1.0, v12
    v_add_f32 v13, 1.0, v13
    v_rcp_f32 v12, v12
    v_rcp_f32 v13, v13
    v_mul_f32 v10, v10, v12
    v_mul_f32 v11, v11, v13
    v_cvt_pk_bf16_f32 v14, v10, v11
    v_lshlrev_b32 v10, 16, v14
    v_and_b32 v11, s90, v14
    v_lshlrev_b32 v7, 3, v0
    v_cmp_gt_u32 vcc, 224, v0
    s_and_saveexec_b64 s[58:59], vcc
    ds_write_b64 v7, v[10:11]
    s_mov_b64 exec, s[58:59]
    s_waitcnt lgkmcnt(0)
    s_barrier
    v_lshrrev_b32 v5, 3, v0
    v_lshlrev_b32 v7, 2, v5
    ds_read_b32 v128, v7 offset:0
    ds_read_b32 v129, v7 offset:128
    ds_read_b32 v130, v7 offset:256
    ds_read_b32 v131, v7 offset:384
    ds_read_b32 v132, v7 offset:512
    ds_read_b32 v133, v7 offset:640
    ds_read_b32 v134, v7 offset:768
    ds_read_b32 v135, v7 offset:896
    ds_read_b32 v136, v7 offset:1024
    ds_read_b32 v137, v7 offset:1152
    ds_read_b32 v138, v7 offset:1280
    ds_read_b32 v139, v7 offset:1408
    ds_read_b32 v140, v7 offset:1536
    ds_read_b32 v141, v7 offset:1664
    v_mov_b32 v160, 0
    v_mov_b32 v161, 0
    v_mov_b32 v162, 0
    v_mov_b32 v163, 0
    v_mov_b32 v164, 0
    v_mov_b32 v165, 0
    v_mov_b32 v166, 0
    v_mov_b32 v167, 0
    v_accvgpr_read_b32 v16, a128
    v_accvgpr_read_b32 v17, a129
    v_accvgpr_read_b32 v18, a130
    v_accvgpr_read_b32 v19, a131
    s_waitcnt lgkmcnt(0)
    v_lshlrev_b32 v24, 16, v16
    v_and_b32 v25, s90, v16
    v_lshlrev_b32 v26, 16, v17
    v_and_b32 v27, s90, v17
    v_lshlrev_b32 v28, 16, v18
    v_and_b32 v29, s90, v18
    v_lshlrev_b32 v30, 16, v19
    v_and_b32 v31, s90, v19
    v_pk_fma_f32 v[160:161], v[24:25], v[128:129], v[160:161] op_sel_hi:[1,0,1]
    v_pk_fma_f32 v[162:163], v[26:27], v[128:129], v[162:163] op_sel_hi:[1,0,1]
    v_pk_fma_f32 v[164:165], v[28:29], v[128:129], v[164:165] op_sel_hi:[1,0,1]
    v_pk_fma_f32 v[166:167], v[30:31], v[128:129], v[166:167] op_sel_hi:[1,0,1]
    v_accvgpr_read_b32 v20, a132
    v_accvgpr_read_b32 v21, a133
    v_accvgpr_read_b32 v22, a134
    v_accvgpr_read_b32 v23, a135
    v_lshlrev_b32 v24, 16, v20
    v_and_b32 v25, s90, v20
    v_lshlrev_b32 v26, 16, v21
    v_and_b32 v27, s90, v21
    v_lshlrev_b32 v28, 16, v22
    v_and_b32 v29, s90, v22
    v_lshlrev_b32 v30, 16, v23
    v_and_b32 v31, s90, v23
    v_pk_fma_f32 v[160:161], v[24:25], v[128:129], v[160:161] op_sel:[0,1,0] op_sel_hi:[1,1,1]
    v_pk_fma_f32 v[162:163], v[26:27], v[128:129], v[162:163] op_sel:[0,1,0] op_sel_hi:[1,1,1]
    v_pk_fma_f32 v[164:165], v[28:29], v[128:129], v[164:165] op_sel:[0,1,0] op_sel_hi:[1,1,1]
    v_pk_fma_f32 v[166:167], v[30:31], v[128:129], v[166:167] op_sel:[0,1,0] op_sel_hi:[1,1,1]
    v_accvgpr_read_b32 v16, a136
    v_accvgpr_read_b32 v17, a137
    v_accvgpr_read_b32 v18, a138
    v_accvgpr_read_b32 v19, a139
    v_lshlrev_b32 v24, 16, v16
    v_and_b32 v25, s90, v16
    v_lshlrev_b32 v26, 16, v17
    v_and_b32 v27, s90, v17
    v_lshlrev_b32 v28, 16, v18
    v_and_b32 v29, s90, v18
    v_lshlrev_b32 v30, 16, v19
    v_and_b32 v31, s90, v19
    v_pk_fma_f32 v[160:161], v[24:25], v[130:131], v[160:161] op_sel_hi:[1,0,1]
    v_pk_fma_f32 v[162:163], v[26:27], v[130:131], v[162:163] op_sel_hi:[1,0,1]
    v_pk_fma_f32 v[164:165], v[28:29], v[130:131], v[164:165] op_sel_hi:[1,0,1]
    v_pk_fma_f32 v[166:167], v[30:31], v[130:131], v[166:167] op_sel_hi:[1,0,1]
    v_accvgpr_read_b32 v20, a140
    v_accvgpr_read_b32 v21, a141
    v_accvgpr_read_b32 v22, a142
    v_accvgpr_read_b32 v23, a143
    v_lshlrev_b32 v24, 16, v20
    v_and_b32 v25, s90, v20
    v_lshlrev_b32 v26, 16, v21
    v_and_b32 v27, s90, v21
    v_lshlrev_b32 v28, 16, v22
    v_and_b32 v29, s90, v22
    v_lshlrev_b32 v30, 16, v23
    v_and_b32 v31, s90, v23
    v_pk_fma_f32 v[160:161], v[24:25], v[130:131], v[160:161] op_sel:[0,1,0] op_sel_hi:[1,1,1]
    v_pk_fma_f32 v[162:163], v[26:27], v[130:131], v[162:163] op_sel:[0,1,0] op_sel_hi:[1,1,1]
    v_pk_fma_f32 v[164:165], v[28:29], v[130:131], v[164:165] op_sel:[0,1,0] op_sel_hi:[1,1,1]
    v_pk_fma_f32 v[166:167], v[30:31], v[130:131], v[166:167] op_sel:[0,1,0] op_sel_hi:[1,1,1]
    v_accvgpr_read_b32 v16, a144
    v_accvgpr_read_b32 v17, a145
    v_accvgpr_read_b32 v18, a146
    v_accvgpr_read_b32 v19, a147
    v_lshlrev_b32 v24, 16, v16
    v_and_b32 v25, s90, v16
    v_lshlrev_b32 v26, 16, v17
    v_and_b32 v27, s90, v17
    v_lshlrev_b32 v28, 16, v18
    v_and_b32 v29, s90, v18
    v_lshlrev_b32 v30, 16, v19
    v_and_b32 v31, s90, v19
    v_pk_fma_f32 v[160:161], v[24:25], v[132:133], v[160:161] op_sel_hi:[1,0,1]
    v_pk_fma_f32 v[162:163], v[26:27], v[132:133], v[162:163] op_sel_hi:[1,0,1]
    v_pk_fma_f32 v[164:165], v[28:29], v[132:133], v[164:165] op_sel_hi:[1,0,1]
    v_pk_fma_f32 v[166:167], v[30:31], v[132:133], v[166:167] op_sel_hi:[1,0,1]
    v_accvgpr_read_b32 v20, a148
    v_accvgpr_read_b32 v21, a149
    v_accvgpr_read_b32 v22, a150
    v_accvgpr_read_b32 v23, a151
    v_lshlrev_b32 v24, 16, v20
    v_and_b32 v25, s90, v20
    v_lshlrev_b32 v26, 16, v21
    v_and_b32 v27, s90, v21
    v_lshlrev_b32 v28, 16, v22
    v_and_b32 v29, s90, v22
    v_lshlrev_b32 v30, 16, v23
    v_and_b32 v31, s90, v23
    v_pk_fma_f32 v[160:161], v[24:25], v[132:133], v[160:161] op_sel:[0,1,0] op_sel_hi:[1,1,1]
    v_pk_fma_f32 v[162:163], v[26:27], v[132:133], v[162:163] op_sel:[0,1,0] op_sel_hi:[1,1,1]
    v_pk_fma_f32 v[164:165], v[28:29], v[132:133], v[164:165] op_sel:[0,1,0] op_sel_hi:[1,1,1]
    v_pk_fma_f32 v[166:167], v[30:31], v[132:133], v[166:167] op_sel:[0,1,0] op_sel_hi:[1,1,1]
    v_accvgpr_read_b32 v16, a152
    v_accvgpr_read_b32 v17, a153
    v_accvgpr_read_b32 v18, a154
    v_accvgpr_read_b32 v19, a155
    v_lshlrev_b32 v24, 16, v16
    v_and_b32 v25, s90, v16
    v_lshlrev_b32 v26, 16, v17
    v_and_b32 v27, s90, v17
    v_lshlrev_b32 v28, 16, v18
    v_and_b32 v29, s90, v18
    v_lshlrev_b32 v30, 16, v19
    v_and_b32 v31, s90, v19
    v_pk_fma_f32 v[160:161], v[24:25], v[134:135], v[160:161] op_sel_hi:[1,0,1]
    v_pk_fma_f32 v[162:163], v[26:27], v[134:135], v[162:163] op_sel_hi:[1,0,1]
    v_pk_fma_f32 v[164:165], v[28:29], v[134:135], v[164:165] op_sel_hi:[1,0,1]
    v_pk_fma_f32 v[166:167], v[30:31], v[134:135], v[166:167] op_sel_hi:[1,0,1]
    v_accvgpr_read_b32 v20, a156
    v_accvgpr_read_b32 v21, a157
    v_accvgpr_read_b32 v22, a158
    v_accvgpr_read_b32 v23, a159
    v_lshlrev_b32 v24, 16, v20
    v_and_b32 v25, s90, v20
    v_lshlrev_b32 v26, 16, v21
    v_and_b32 v27, s90, v21
    v_lshlrev_b32 v28, 16, v22
    v_and_b32 v29, s90, v22
    v_lshlrev_b32 v30, 16, v23
    v_and_b32 v31, s90, v23
    v_pk_fma_f32 v[160:161], v[24:25], v[134:135], v[160:161] op_sel:[0,1,0] op_sel_hi:[1,1,1]
    v_pk_fma_f32 v[162:163], v[26:27], v[134:135], v[162:163] op_sel:[0,1,0] op_sel_hi:[1,1,1]
    v_pk_fma_f32 v[164:165], v[28:29], v[134:135], v[164:165] op_sel:[0,1,0] op_sel_hi:[1,1,1]
    v_pk_fma_f32 v[166:167], v[30:31], v[134:135], v[166:167] op_sel:[0,1,0] op_sel_hi:[1,1,1]
    v_accvgpr_read_b32 v16, a160
    v_accvgpr_read_b32 v17, a161
    v_accvgpr_read_b32 v18, a162
    v_accvgpr_read_b32 v19, a163
    v_lshlrev_b32 v24, 16, v16
    v_and_b32 v25, s90, v16
    v_lshlrev_b32 v26, 16, v17
    v_and_b32 v27, s90, v17
    v_lshlrev_b32 v28, 16, v18
    v_and_b32 v29, s90, v18
    v_lshlrev_b32 v30, 16, v19
    v_and_b32 v31, s90, v19
    v_pk_fma_f32 v[160:161], v[24:25], v[136:137], v[160:161] op_sel_hi:[1,0,1]
    v_pk_fma_f32 v[162:163], v[26:27], v[136:137], v[162:163] op_sel_hi:[1,0,1]
    v_pk_fma_f32 v[164:165], v[28:29], v[136:137], v[164:165] op_sel_hi:[1,0,1]
    v_pk_fma_f32 v[166:167], v[30:31], v[136:137], v[166:167] op_sel_hi:[1,0,1]
    v_accvgpr_read_b32 v20, a164
    v_accvgpr_read_b32 v21, a165
    v_accvgpr_read_b32 v22, a166
    v_accvgpr_read_b32 v23, a167
    v_lshlrev_b32 v24, 16, v20
    v_and_b32 v25, s90, v20
    v_lshlrev_b32 v26, 16, v21
    v_and_b32 v27, s90, v21
    v_lshlrev_b32 v28, 16, v22
    v_and_b32 v29, s90, v22
    v_lshlrev_b32 v30, 16, v23
    v_and_b32 v31, s90, v23
    v_pk_fma_f32 v[160:161], v[24:25], v[136:137], v[160:161] op_sel:[0,1,0] op_sel_hi:[1,1,1]
    v_pk_fma_f32 v[162:163], v[26:27], v[136:137], v[162:163] op_sel:[0,1,0] op_sel_hi:[1,1,1]
    v_pk_fma_f32 v[164:165], v[28:29], v[136:137], v[164:165] op_sel:[0,1,0] op_sel_hi:[1,1,1]
    v_pk_fma_f32 v[166:167], v[30:31], v[136:137], v[166:167] op_sel:[0,1,0] op_sel_hi:[1,1,1]
    v_accvgpr_read_b32 v16, a168
    v_accvgpr_read_b32 v17, a169
    v_accvgpr_read_b32 v18, a170
    v_accvgpr_read_b32 v19, a171
    v_lshlrev_b32 v24, 16, v16
    v_and_b32 v25, s90, v16
    v_lshlrev_b32 v26, 16, v17
    v_and_b32 v27, s90, v17
    v_lshlrev_b32 v28, 16, v18
    v_and_b32 v29, s90, v18
    v_lshlrev_b32 v30, 16, v19
    v_and_b32 v31, s90, v19
    v_pk_fma_f32 v[160:161], v[24:25], v[138:139], v[160:161] op_sel_hi:[1,0,1]
    v_pk_fma_f32 v[162:163], v[26:27], v[138:139], v[162:163] op_sel_hi:[1,0,1]
    v_pk_fma_f32 v[164:165], v[28:29], v[138:139], v[164:165] op_sel_hi:[1,0,1]
    v_pk_fma_f32 v[166:167], v[30:31], v[138:139], v[166:167] op_sel_hi:[1,0,1]
    v_accvgpr_read_b32 v20, a172
    v_accvgpr_read_b32 v21, a173
    v_accvgpr_read_b32 v22, a174
    v_accvgpr_read_b32 v23, a175
    v_lshlrev_b32 v24, 16, v20
    v_and_b32 v25, s90, v20
    v_lshlrev_b32 v26, 16, v21
    v_and_b32 v27, s90, v21
    v_lshlrev_b32 v28, 16, v22
    v_and_b32 v29, s90, v22
    v_lshlrev_b32 v30, 16, v23
    v_and_b32 v31, s90, v23
    v_pk_fma_f32 v[160:161], v[24:25], v[138:139], v[160:161] op_sel:[0,1,0] op_sel_hi:[1,1,1]
    v_pk_fma_f32 v[162:163], v[26:27], v[138:139], v[162:163] op_sel:[0,1,0] op_sel_hi:[1,1,1]
    v_pk_fma_f32 v[164:165], v[28:29], v[138:139], v[164:165] op_sel:[0,1,0] op_sel_hi:[1,1,1]
    v_pk_fma_f32 v[166:167], v[30:31], v[138:139], v[166:167] op_sel:[0,1,0] op_sel_hi:[1,1,1]
    v_accvgpr_read_b32 v16, a176
    v_accvgpr_read_b32 v17, a177
    v_accvgpr_read_b32 v18, a178
    v_accvgpr_read_b32 v19, a179
    v_lshlrev_b32 v24, 16, v16
    v_and_b32 v25, s90, v16
    v_lshlrev_b32 v26, 16, v17
    v_and_b32 v27, s90, v17
    v_lshlrev_b32 v28, 16, v18
    v_and_b32 v29, s90, v18
    v_lshlrev_b32 v30, 16, v19
    v_and_b32 v31, s90, v19
    v_pk_fma_f32 v[160:161], v[24:25], v[140:141], v[160:161] op_sel_hi:[1,0,1]
    v_pk_fma_f32 v[162:163], v[26:27], v[140:141], v[162:163] op_sel_hi:[1,0,1]
    v_pk_fma_f32 v[164:165], v[28:29], v[140:141], v[164:165] op_sel_hi:[1,0,1]
    v_pk_fma_f32 v[166:167], v[30:31], v[140:141], v[166:167] op_sel_hi:[1,0,1]
    v_accvgpr_read_b32 v20, a180
    v_accvgpr_read_b32 v21, a181
    v_accvgpr_read_b32 v22, a182
    v_accvgpr_read_b32 v23, a183
    v_lshlrev_b32 v24, 16, v20
    v_and_b32 v25, s90, v20
    v_lshlrev_b32 v26, 16, v21
    v_and_b32 v27, s90, v21
    v_lshlrev_b32 v28, 16, v22
    v_and_b32 v29, s90, v22
    v_lshlrev_b32 v30, 16, v23
    v_and_b32 v31, s90, v23
    v_pk_fma_f32 v[160:161], v[24:25], v[140:141], v[160:161] op_sel:[0,1,0] op_sel_hi:[1,1,1]
    v_pk_fma_f32 v[162:163], v[26:27], v[140:141], v[162:163] op_sel:[0,1,0] op_sel_hi:[1,1,1]
    v_pk_fma_f32 v[164:165], v[28:29], v[140:141], v[164:165] op_sel:[0,1,0] op_sel_hi:[1,1,1]
    v_pk_fma_f32 v[166:167], v[30:31], v[140:141], v[166:167] op_sel:[0,1,0] op_sel_hi:[1,1,1]
    v_and_b32 v4, 7, v0
    v_lshlrev_b32 v7, 8, v5
    v_lshl_add_u32 v7, v4, 5, v7
    ds_write_b128 v7, v[160:163] offset:2048
    ds_write_b128 v7, v[164:167] offset:2064
    s_waitcnt lgkmcnt(0)
    s_barrier
    v_lshlrev_b32 v7, 2, v1
    s_lshl_b32 s56, s91, 11
    v_add_u32 v4, s56, v7
    ds_read_b32 v16, v4 offset:2048
    ds_read_b32 v17, v4 offset:2304
    ds_read_b32 v18, v4 offset:2560
    ds_read_b32 v19, v4 offset:2816
    ds_read_b32 v20, v4 offset:3072
    ds_read_b32 v21, v4 offset:3328
    ds_read_b32 v22, v4 offset:3584
    ds_read_b32 v23, v4 offset:3840
    s_waitcnt lgkmcnt(0)
    v_add_f32 v16, v16, v17
    v_add_f32 v18, v18, v19
    v_add_f32 v20, v20, v21
    v_add_f32 v22, v22, v23
    v_add_f32 v16, v16, v18
    v_add_f32 v20, v20, v22
    v_add_f32 v16, v16, v20
    s_lshl_b32 s56, s91, 8
    v_add_u32 v4, s56, v7
    ds_write_b32 v4, v16 offset:10240
    s_waitcnt lgkmcnt(0)
    s_barrier
    s_cmp_lg_u32 s91, 0
    s_cbranch_scc1 L_w0_30
    ds_read_b32 v16, v7 offset:10240
    ds_read_b32 v17, v7 offset:10496
    ds_read_b32 v18, v7 offset:10752
    ds_read_b32 v19, v7 offset:11008
    s_waitcnt lgkmcnt(0)
    v_add_f32 v16, v16, v17
    v_add_f32 v18, v18, v19
    v_add_f32 v16, v16, v18
    v_cvt_pk_bf16_f32 v17, v16, v16
    v_and_b32 v16, s90, v17
    s_add_u32 s40, s30, 4194304
    s_addc_u32 s41, s31, 0
    s_mov_b32 s42, 10752
    s_mov_b32 s43, 0x20000
    s_lshl_b32 s56, s99, 8
    v_add_u32 v7, s56, v7
    buffer_store_dword v16, v7, s[40:43], 0 offen sc1
    s_waitcnt vmcnt(0)
L_w0_30:
    s_lshl_b32 s57, s99, 6
    s_cmp_lg_u32 s91, 0
    s_cbranch_scc1 L_w0_31
    s_add_u32 s56, s57, 36864
    v_mov_b32 v250, s56
    v_mov_b32 v252, s88
    v_mov_b32 v253, s89
    s_mov_b64 exec, 1
    buffer_store_dwordx2 v[252:253], v250, s[52:55], 0 offen sc1
    s_mov_b64 exec, -1
L_w0_31:
L_nomod2_29:
    s_cmp_lg_u32 s2, 248
    s_cbranch_scc1 L_fin
    v_lshlrev_b32 v35, 6, v1
    v_add_u32 v35, 4096, v35
    v_add_u32 v36, 4096, v35
    v_add_u32 v37, 8192, v35
    v_add_u32 v38, 192, v1
    v_and_b32 v39, 7, v38
    v_cmp_eq_u32 vcc, 7, v39
    v_mov_b32 v39, 224
    v_cmp_le_u32 s[60:61], v39, v38
    s_and_b64 vcc, vcc, s[60:61]
    v_cndmask_b32 v38, v38, 0, vcc
    v_lshlrev_b32 v38, 6, v38
    v_add_u32 v38, 4096, v38
    s_or_b32 s59, s89, 15
    s_mov_b32 s58, s88
    s_cmp_lg_u32 s91, 0
    s_cbranch_scc1 L_w0_32
    s_mov_b32 s56, 0
L_poll_33:
    buffer_load_dwordx2 v[240:241], v35, s[52:55], 0 offen sc1
    buffer_load_dwordx2 v[242:243], v36, s[52:55], 0 offen sc1
    buffer_load_dwordx2 v[244:245], v37, s[52:55], 0 offen sc1
    buffer_load_dwordx2 v[246:247], v38, s[52:55], 0 offen sc1
    s_waitcnt vmcnt(0)
L_pfirst_35:
    v_or_b32 v241, 15, v241
    v_cmp_ne_u64 vcc, s[58:59], v[240:241]
    v_or_b32 v243, 15, v243
    v_cmp_ne_u64 s[60:61], s[58:59], v[242:243]
    s_or_b64 vcc, vcc, s[60:61]
    v_or_b32 v245, 15, v245
    v_cmp_ne_u64 s[60:61], s[58:59], v[244:245]
    s_or_b64 vcc, vcc, s[60:61]
    v_or_b32 v247, 15, v247
    v_cmp_ne_u64 s[60:61], s[58:59], v[246:247]
    s_or_b64 vcc, vcc, s[60:61]
    s_cmp_eq_u64 vcc, 0
    s_cbranch_scc1 L_pdone_34
    s_add_u32 s56, s56, 1
    s_cmp_lt_u32 s56, 131072
    s_cbranch_scc1 L_poll_33
L_pdone_34:
L_w0_32:
    s_cmp_lg_u32 s91, 0
    s_cbranch_scc1 L_w0_36
    v_mov_b32 v250, 0
    v_mov_b32 v252, s88
    v_mov_b32 v253, s89
    s_mov_b64 exec, 1
    buffer_store_dwordx2 v[252:253], v250, s[52:55], 0 offen sc1
    s_mov_b64 exec, -1
L_w0_36:
    s_branch L_fin
L_aux:
    s_cmp_lt_u32 s93, 21
    s_cbranch_scc1 L_mod_38
    s_sub_u32 s64, s62, 4
    s_subb_u32 s65, s63, 0
    s_mov_b32 s66, (L_code_end - adaLN_cond__ssm_conv_h3__dense_activation_silu__prompt_kernel)
    s_mov_b32 s67, 0x20000
    s_lshl_b32 s56, s93, 2
    s_add_u32 s56, s56, s91
    s_mul_i32 s56, s56, 384
    v_and_b32 v238, 3, v1
    v_lshlrev_b32 v238, 7, v238
    v_add_u32 v238, s56, v238
    s_mov_b64 exec, 7
    buffer_load_dword v239, v238, s[64:67], 0 offen
    s_mov_b64 exec, -1
    s_waitcnt lgkmcnt(0)
    s_add_u32 s88, s88, 1
    s_addc_u32 s89, s89, 0
    s_cmp_lg_u32 s91, 0
    s_cbranch_scc1 L_w0_39
    s_andn2_b32 s56, s89, 15
    s_or_b32 s56, s56, s97
    s_lshl_b32 s57, s2, 6
    s_add_u32 s57, s57, 4096
    v_mov_b32 v250, s57
    v_mov_b32 v252, s88
    v_mov_b32 v253, s56
    s_mov_b64 exec, 1
    buffer_store_dwordx2 v[252:253], v250, s[52:55], 0 offen sc1
    s_lshl_b32 s57, s92, 5
    s_add_u32 s57, s57, s93
    s_lshl_b32 s57, s57, 6
    s_add_u32 s57, s57, 20480
    s_mul_i32 s56, s95, 7
    s_add_u32 s56, s56, s96
    s_lshl_b32 s56, s56, 6
    s_add_u32 s56, s56, 57344
    s_mov_b64 exec, 3
    v_mov_b32 v250, s57
    v_writelane_b32 v250, s56, 1
    buffer_load_dword v251, v250, s[52:55], 0 offen sc1
    s_mov_b64 exec, -1
L_w0_39:
    s_branch L_nomod_37
L_mod_38:
    s_mov_b32 s32, s24
    s_mov_b32 s33, s25
    s_mov_b32 s34, 2408448
    s_mov_b32 s35, 0x20000
    s_mov_b32 s36, s22
    s_mov_b32 s37, s23
    s_mov_b32 s38, 896
    s_mov_b32 s39, 0x20000
    s_lshl_b32 s56, s93, 7
    v_and_b32 v238, 7, v0
    v_lshrrev_b32 v237, 3, v0
    v_mul_u32_u24 v237, 5376, v237
    v_lshl_add_u32 v237, v238, 4, v237
    v_add_u32 v237, s56, v237
    v_lshlrev_b32 v238, 2, v0
    buffer_load_dword a184, v238, s[36:39], 0 offen
    s_mov_b32 s71, 0
    buffer_load_dwordx4 a[128:131], v237, s[32:35], s71 offen
    s_mov_b32 s71, 172032
    buffer_load_dwordx4 a[132:135], v237, s[32:35], s71 offen
    s_mov_b32 s71, 344064
    buffer_load_dwordx4 a[136:139], v237, s[32:35], s71 offen
    s_mov_b32 s71, 516096
    buffer_load_dwordx4 a[140:143], v237, s[32:35], s71 offen
    s_mov_b32 s71, 688128
    buffer_load_dwordx4 a[144:147], v237, s[32:35], s71 offen
    s_mov_b32 s71, 860160
    buffer_load_dwordx4 a[148:151], v237, s[32:35], s71 offen
    s_mov_b32 s71, 1032192
    buffer_load_dwordx4 a[152:155], v237, s[32:35], s71 offen
    s_mov_b32 s71, 1204224
    buffer_load_dwordx4 a[156:159], v237, s[32:35], s71 offen
    s_mov_b32 s71, 1376256
    buffer_load_dwordx4 a[160:163], v237, s[32:35], s71 offen
    s_mov_b32 s71, 1548288
    buffer_load_dwordx4 a[164:167], v237, s[32:35], s71 offen
    s_mov_b32 s71, 1720320
    buffer_load_dwordx4 a[168:171], v237, s[32:35], s71 offen
    s_mov_b32 s71, 1892352
    buffer_load_dwordx4 a[172:175], v237, s[32:35], s71 offen
    s_mov_b32 s71, 2064384
    buffer_load_dwordx4 a[176:179], v237, s[32:35], s71 offen
    s_mov_b32 s71, 2236416
    buffer_load_dwordx4 a[180:183], v237, s[32:35], s71 offen
    s_sub_u32 s64, s62, 4
    s_subb_u32 s65, s63, 0
    s_mov_b32 s66, (L_code_end - adaLN_cond__ssm_conv_h3__dense_activation_silu__prompt_kernel)
    s_mov_b32 s67, 0x20000
    s_lshl_b32 s56, s93, 2
    s_add_u32 s56, s56, s91
    s_mul_i32 s56, s56, 384
    v_and_b32 v238, 3, v1
    v_lshlrev_b32 v238, 7, v238
    v_add_u32 v238, s56, v238
    s_mov_b64 exec, 7
    buffer_load_dword v239, v238, s[64:67], 0 offen
    s_mov_b64 exec, -1
    s_waitcnt lgkmcnt(0)
    s_add_u32 s88, s88, 1
    s_addc_u32 s89, s89, 0
    s_cmp_lg_u32 s91, 0
    s_cbranch_scc1 L_w0_40
    s_andn2_b32 s56, s89, 15
    s_or_b32 s56, s56, s97
    s_lshl_b32 s57, s2, 6
    s_add_u32 s57, s57, 4096
    v_mov_b32 v250, s57
    v_mov_b32 v252, s88
    v_mov_b32 v253, s56
    s_mov_b64 exec, 1
    buffer_store_dwordx2 v[252:253], v250, s[52:55], 0 offen sc1
    s_lshl_b32 s57, s92, 5
    s_add_u32 s57, s57, s93
    s_lshl_b32 s57, s57, 6
    s_add_u32 s57, s57, 20480
    s_mul_i32 s56, s95, 7
    s_add_u32 s56, s56, s96
    s_lshl_b32 s56, s56, 6
    s_add_u32 s56, s56, 57344
    s_mov_b64 exec, 3
    v_mov_b32 v250, s57
    v_writelane_b32 v250, s56, 1
    buffer_load_dword v251, v250, s[52:55], 0 offen sc1
    s_mov_b64 exec, -1
L_w0_40:
    s_waitcnt vmcnt(0)
    v_accvgpr_read_b32 v8, a184
    v_lshlrev_b32 v10, 16, v8
    v_and_b32 v11, s90, v8
    v_mul_f32 v12, 0xbfb8aa3b, v10
    v_mul_f32 v13, 0xbfb8aa3b, v11
    v_exp_f32 v12, v12
    v_exp_f32 v13, v13
    v_add_f32 v12, 1.0, v12
    v_add_f32 v13, 1.0, v13
    v_rcp_f32 v12, v12
    v_rcp_f32 v13, v13
    v_mul_f32 v10, v10, v12
    v_mul_f32 v11, v11, v13
    v_cvt_pk_bf16_f32 v14, v10, v11
    v_lshlrev_b32 v10, 16, v14
    v_and_b32 v11, s90, v14
    v_lshlrev_b32 v7, 3, v0
    v_cmp_gt_u32 vcc, 224, v0
    s_and_saveexec_b64 s[58:59], vcc
    ds_write_b64 v7, v[10:11]
    s_mov_b64 exec, s[58:59]
    s_waitcnt lgkmcnt(0)
    s_barrier
    v_lshrrev_b32 v5, 3, v0
    v_lshlrev_b32 v7, 2, v5
    ds_read_b32 v128, v7 offset:0
    ds_read_b32 v129, v7 offset:128
    ds_read_b32 v130, v7 offset:256
    ds_read_b32 v131, v7 offset:384
    ds_read_b32 v132, v7 offset:512
    ds_read_b32 v133, v7 offset:640
    ds_read_b32 v134, v7 offset:768
    ds_read_b32 v135, v7 offset:896
    ds_read_b32 v136, v7 offset:1024
    ds_read_b32 v137, v7 offset:1152
    ds_read_b32 v138, v7 offset:1280
    ds_read_b32 v139, v7 offset:1408
    ds_read_b32 v140, v7 offset:1536
    ds_read_b32 v141, v7 offset:1664
    v_mov_b32 v160, 0
    v_mov_b32 v161, 0
    v_mov_b32 v162, 0
    v_mov_b32 v163, 0
    v_mov_b32 v164, 0
    v_mov_b32 v165, 0
    v_mov_b32 v166, 0
    v_mov_b32 v167, 0
    v_accvgpr_read_b32 v16, a128
    v_accvgpr_read_b32 v17, a129
    v_accvgpr_read_b32 v18, a130
    v_accvgpr_read_b32 v19, a131
    s_waitcnt lgkmcnt(0)
    v_lshlrev_b32 v24, 16, v16
    v_and_b32 v25, s90, v16
    v_lshlrev_b32 v26, 16, v17
    v_and_b32 v27, s90, v17
    v_lshlrev_b32 v28, 16, v18
    v_and_b32 v29, s90, v18
    v_lshlrev_b32 v30, 16, v19
    v_and_b32 v31, s90, v19
    v_pk_fma_f32 v[160:161], v[24:25], v[128:129], v[160:161] op_sel_hi:[1,0,1]
    v_pk_fma_f32 v[162:163], v[26:27], v[128:129], v[162:163] op_sel_hi:[1,0,1]
    v_pk_fma_f32 v[164:165], v[28:29], v[128:129], v[164:165] op_sel_hi:[1,0,1]
    v_pk_fma_f32 v[166:167], v[30:31], v[128:129], v[166:167] op_sel_hi:[1,0,1]
    v_accvgpr_read_b32 v20, a132
    v_accvgpr_read_b32 v21, a133
    v_accvgpr_read_b32 v22, a134
    v_accvgpr_read_b32 v23, a135
    v_lshlrev_b32 v24, 16, v20
    v_and_b32 v25, s90, v20
    v_lshlrev_b32 v26, 16, v21
    v_and_b32 v27, s90, v21
    v_lshlrev_b32 v28, 16, v22
    v_and_b32 v29, s90, v22
    v_lshlrev_b32 v30, 16, v23
    v_and_b32 v31, s90, v23
    v_pk_fma_f32 v[160:161], v[24:25], v[128:129], v[160:161] op_sel:[0,1,0] op_sel_hi:[1,1,1]
    v_pk_fma_f32 v[162:163], v[26:27], v[128:129], v[162:163] op_sel:[0,1,0] op_sel_hi:[1,1,1]
    v_pk_fma_f32 v[164:165], v[28:29], v[128:129], v[164:165] op_sel:[0,1,0] op_sel_hi:[1,1,1]
    v_pk_fma_f32 v[166:167], v[30:31], v[128:129], v[166:167] op_sel:[0,1,0] op_sel_hi:[1,1,1]
    v_accvgpr_read_b32 v16, a136
    v_accvgpr_read_b32 v17, a137
    v_accvgpr_read_b32 v18, a138
    v_accvgpr_read_b32 v19, a139
    v_lshlrev_b32 v24, 16, v16
    v_and_b32 v25, s90, v16
    v_lshlrev_b32 v26, 16, v17
    v_and_b32 v27, s90, v17
    v_lshlrev_b32 v28, 16, v18
    v_and_b32 v29, s90, v18
    v_lshlrev_b32 v30, 16, v19
    v_and_b32 v31, s90, v19
    v_pk_fma_f32 v[160:161], v[24:25], v[130:131], v[160:161] op_sel_hi:[1,0,1]
    v_pk_fma_f32 v[162:163], v[26:27], v[130:131], v[162:163] op_sel_hi:[1,0,1]
    v_pk_fma_f32 v[164:165], v[28:29], v[130:131], v[164:165] op_sel_hi:[1,0,1]
    v_pk_fma_f32 v[166:167], v[30:31], v[130:131], v[166:167] op_sel_hi:[1,0,1]
    v_accvgpr_read_b32 v20, a140
    v_accvgpr_read_b32 v21, a141
    v_accvgpr_read_b32 v22, a142
    v_accvgpr_read_b32 v23, a143
    v_lshlrev_b32 v24, 16, v20
    v_and_b32 v25, s90, v20
    v_lshlrev_b32 v26, 16, v21
    v_and_b32 v27, s90, v21
    v_lshlrev_b32 v28, 16, v22
    v_and_b32 v29, s90, v22
    v_lshlrev_b32 v30, 16, v23
    v_and_b32 v31, s90, v23
    v_pk_fma_f32 v[160:161], v[24:25], v[130:131], v[160:161] op_sel:[0,1,0] op_sel_hi:[1,1,1]
    v_pk_fma_f32 v[162:163], v[26:27], v[130:131], v[162:163] op_sel:[0,1,0] op_sel_hi:[1,1,1]
    v_pk_fma_f32 v[164:165], v[28:29], v[130:131], v[164:165] op_sel:[0,1,0] op_sel_hi:[1,1,1]
    v_pk_fma_f32 v[166:167], v[30:31], v[130:131], v[166:167] op_sel:[0,1,0] op_sel_hi:[1,1,1]
    v_accvgpr_read_b32 v16, a144
    v_accvgpr_read_b32 v17, a145
    v_accvgpr_read_b32 v18, a146
    v_accvgpr_read_b32 v19, a147
    v_lshlrev_b32 v24, 16, v16
    v_and_b32 v25, s90, v16
    v_lshlrev_b32 v26, 16, v17
    v_and_b32 v27, s90, v17
    v_lshlrev_b32 v28, 16, v18
    v_and_b32 v29, s90, v18
    v_lshlrev_b32 v30, 16, v19
    v_and_b32 v31, s90, v19
    v_pk_fma_f32 v[160:161], v[24:25], v[132:133], v[160:161] op_sel_hi:[1,0,1]
    v_pk_fma_f32 v[162:163], v[26:27], v[132:133], v[162:163] op_sel_hi:[1,0,1]
    v_pk_fma_f32 v[164:165], v[28:29], v[132:133], v[164:165] op_sel_hi:[1,0,1]
    v_pk_fma_f32 v[166:167], v[30:31], v[132:133], v[166:167] op_sel_hi:[1,0,1]
    v_accvgpr_read_b32 v20, a148
    v_accvgpr_read_b32 v21, a149
    v_accvgpr_read_b32 v22, a150
    v_accvgpr_read_b32 v23, a151
    v_lshlrev_b32 v24, 16, v20
    v_and_b32 v25, s90, v20
    v_lshlrev_b32 v26, 16, v21
    v_and_b32 v27, s90, v21
    v_lshlrev_b32 v28, 16, v22
    v_and_b32 v29, s90, v22
    v_lshlrev_b32 v30, 16, v23
    v_and_b32 v31, s90, v23
    v_pk_fma_f32 v[160:161], v[24:25], v[132:133], v[160:161] op_sel:[0,1,0] op_sel_hi:[1,1,1]
    v_pk_fma_f32 v[162:163], v[26:27], v[132:133], v[162:163] op_sel:[0,1,0] op_sel_hi:[1,1,1]
    v_pk_fma_f32 v[164:165], v[28:29], v[132:133], v[164:165] op_sel:[0,1,0] op_sel_hi:[1,1,1]
    v_pk_fma_f32 v[166:167], v[30:31], v[132:133], v[166:167] op_sel:[0,1,0] op_sel_hi:[1,1,1]
    v_accvgpr_read_b32 v16, a152
    v_accvgpr_read_b32 v17, a153
    v_accvgpr_read_b32 v18, a154
    v_accvgpr_read_b32 v19, a155
    v_lshlrev_b32 v24, 16, v16
    v_and_b32 v25, s90, v16
    v_lshlrev_b32 v26, 16, v17
    v_and_b32 v27, s90, v17
    v_lshlrev_b32 v28, 16, v18
    v_and_b32 v29, s90, v18
    v_lshlrev_b32 v30, 16, v19
    v_and_b32 v31, s90, v19
    v_pk_fma_f32 v[160:161], v[24:25], v[134:135], v[160:161] op_sel_hi:[1,0,1]
    v_pk_fma_f32 v[162:163], v[26:27], v[134:135], v[162:163] op_sel_hi:[1,0,1]
    v_pk_fma_f32 v[164:165], v[28:29], v[134:135], v[164:165] op_sel_hi:[1,0,1]
    v_pk_fma_f32 v[166:167], v[30:31], v[134:135], v[166:167] op_sel_hi:[1,0,1]
    v_accvgpr_read_b32 v20, a156
    v_accvgpr_read_b32 v21, a157
    v_accvgpr_read_b32 v22, a158
    v_accvgpr_read_b32 v23, a159
    v_lshlrev_b32 v24, 16, v20
    v_and_b32 v25, s90, v20
    v_lshlrev_b32 v26, 16, v21
    v_and_b32 v27, s90, v21
    v_lshlrev_b32 v28, 16, v22
    v_and_b32 v29, s90, v22
    v_lshlrev_b32 v30, 16, v23
    v_and_b32 v31, s90, v23
    v_pk_fma_f32 v[160:161], v[24:25], v[134:135], v[160:161] op_sel:[0,1,0] op_sel_hi:[1,1,1]
    v_pk_fma_f32 v[162:163], v[26:27], v[134:135], v[162:163] op_sel:[0,1,0] op_sel_hi:[1,1,1]
    v_pk_fma_f32 v[164:165], v[28:29], v[134:135], v[164:165] op_sel:[0,1,0] op_sel_hi:[1,1,1]
    v_pk_fma_f32 v[166:167], v[30:31], v[134:135], v[166:167] op_sel:[0,1,0] op_sel_hi:[1,1,1]
    v_accvgpr_read_b32 v16, a160
    v_accvgpr_read_b32 v17, a161
    v_accvgpr_read_b32 v18, a162
    v_accvgpr_read_b32 v19, a163
    v_lshlrev_b32 v24, 16, v16
    v_and_b32 v25, s90, v16
    v_lshlrev_b32 v26, 16, v17
    v_and_b32 v27, s90, v17
    v_lshlrev_b32 v28, 16, v18
    v_and_b32 v29, s90, v18
    v_lshlrev_b32 v30, 16, v19
    v_and_b32 v31, s90, v19
    v_pk_fma_f32 v[160:161], v[24:25], v[136:137], v[160:161] op_sel_hi:[1,0,1]
    v_pk_fma_f32 v[162:163], v[26:27], v[136:137], v[162:163] op_sel_hi:[1,0,1]
    v_pk_fma_f32 v[164:165], v[28:29], v[136:137], v[164:165] op_sel_hi:[1,0,1]
    v_pk_fma_f32 v[166:167], v[30:31], v[136:137], v[166:167] op_sel_hi:[1,0,1]
    v_accvgpr_read_b32 v20, a164
    v_accvgpr_read_b32 v21, a165
    v_accvgpr_read_b32 v22, a166
    v_accvgpr_read_b32 v23, a167
    v_lshlrev_b32 v24, 16, v20
    v_and_b32 v25, s90, v20
    v_lshlrev_b32 v26, 16, v21
    v_and_b32 v27, s90, v21
    v_lshlrev_b32 v28, 16, v22
    v_and_b32 v29, s90, v22
    v_lshlrev_b32 v30, 16, v23
    v_and_b32 v31, s90, v23
    v_pk_fma_f32 v[160:161], v[24:25], v[136:137], v[160:161] op_sel:[0,1,0] op_sel_hi:[1,1,1]
    v_pk_fma_f32 v[162:163], v[26:27], v[136:137], v[162:163] op_sel:[0,1,0] op_sel_hi:[1,1,1]
    v_pk_fma_f32 v[164:165], v[28:29], v[136:137], v[164:165] op_sel:[0,1,0] op_sel_hi:[1,1,1]
    v_pk_fma_f32 v[166:167], v[30:31], v[136:137], v[166:167] op_sel:[0,1,0] op_sel_hi:[1,1,1]
    v_accvgpr_read_b32 v16, a168
    v_accvgpr_read_b32 v17, a169
    v_accvgpr_read_b32 v18, a170
    v_accvgpr_read_b32 v19, a171
    v_lshlrev_b32 v24, 16, v16
    v_and_b32 v25, s90, v16
    v_lshlrev_b32 v26, 16, v17
    v_and_b32 v27, s90, v17
    v_lshlrev_b32 v28, 16, v18
    v_and_b32 v29, s90, v18
    v_lshlrev_b32 v30, 16, v19
    v_and_b32 v31, s90, v19
    v_pk_fma_f32 v[160:161], v[24:25], v[138:139], v[160:161] op_sel_hi:[1,0,1]
    v_pk_fma_f32 v[162:163], v[26:27], v[138:139], v[162:163] op_sel_hi:[1,0,1]
    v_pk_fma_f32 v[164:165], v[28:29], v[138:139], v[164:165] op_sel_hi:[1,0,1]
    v_pk_fma_f32 v[166:167], v[30:31], v[138:139], v[166:167] op_sel_hi:[1,0,1]
    v_accvgpr_read_b32 v20, a172
    v_accvgpr_read_b32 v21, a173
    v_accvgpr_read_b32 v22, a174
    v_accvgpr_read_b32 v23, a175
    v_lshlrev_b32 v24, 16, v20
    v_and_b32 v25, s90, v20
    v_lshlrev_b32 v26, 16, v21
    v_and_b32 v27, s90, v21
    v_lshlrev_b32 v28, 16, v22
    v_and_b32 v29, s90, v22
    v_lshlrev_b32 v30, 16, v23
    v_and_b32 v31, s90, v23
    v_pk_fma_f32 v[160:161], v[24:25], v[138:139], v[160:161] op_sel:[0,1,0] op_sel_hi:[1,1,1]
    v_pk_fma_f32 v[162:163], v[26:27], v[138:139], v[162:163] op_sel:[0,1,0] op_sel_hi:[1,1,1]
    v_pk_fma_f32 v[164:165], v[28:29], v[138:139], v[164:165] op_sel:[0,1,0] op_sel_hi:[1,1,1]
    v_pk_fma_f32 v[166:167], v[30:31], v[138:139], v[166:167] op_sel:[0,1,0] op_sel_hi:[1,1,1]
    v_accvgpr_read_b32 v16, a176
    v_accvgpr_read_b32 v17, a177
    v_accvgpr_read_b32 v18, a178
    v_accvgpr_read_b32 v19, a179
    v_lshlrev_b32 v24, 16, v16
    v_and_b32 v25, s90, v16
    v_lshlrev_b32 v26, 16, v17
    v_and_b32 v27, s90, v17
    v_lshlrev_b32 v28, 16, v18
    v_and_b32 v29, s90, v18
    v_lshlrev_b32 v30, 16, v19
    v_and_b32 v31, s90, v19
    v_pk_fma_f32 v[160:161], v[24:25], v[140:141], v[160:161] op_sel_hi:[1,0,1]
    v_pk_fma_f32 v[162:163], v[26:27], v[140:141], v[162:163] op_sel_hi:[1,0,1]
    v_pk_fma_f32 v[164:165], v[28:29], v[140:141], v[164:165] op_sel_hi:[1,0,1]
    v_pk_fma_f32 v[166:167], v[30:31], v[140:141], v[166:167] op_sel_hi:[1,0,1]
    v_accvgpr_read_b32 v20, a180
    v_accvgpr_read_b32 v21, a181
    v_accvgpr_read_b32 v22, a182
    v_accvgpr_read_b32 v23, a183
    v_lshlrev_b32 v24, 16, v20
    v_and_b32 v25, s90, v20
    v_lshlrev_b32 v26, 16, v21
    v_and_b32 v27, s90, v21
    v_lshlrev_b32 v28, 16, v22
    v_and_b32 v29, s90, v22
    v_lshlrev_b32 v30, 16, v23
    v_and_b32 v31, s90, v23
    v_pk_fma_f32 v[160:161], v[24:25], v[140:141], v[160:161] op_sel:[0,1,0] op_sel_hi:[1,1,1]
    v_pk_fma_f32 v[162:163], v[26:27], v[140:141], v[162:163] op_sel:[0,1,0] op_sel_hi:[1,1,1]
    v_pk_fma_f32 v[164:165], v[28:29], v[140:141], v[164:165] op_sel:[0,1,0] op_sel_hi:[1,1,1]
    v_pk_fma_f32 v[166:167], v[30:31], v[140:141], v[166:167] op_sel:[0,1,0] op_sel_hi:[1,1,1]
    v_and_b32 v4, 7, v0
    v_lshlrev_b32 v7, 8, v5
    v_lshl_add_u32 v7, v4, 5, v7
    ds_write_b128 v7, v[160:163] offset:2048
    ds_write_b128 v7, v[164:167] offset:2064
    s_waitcnt lgkmcnt(0)
    s_barrier
    v_lshlrev_b32 v7, 2, v1
    s_lshl_b32 s56, s91, 11
    v_add_u32 v4, s56, v7
    ds_read_b32 v16, v4 offset:2048
    ds_read_b32 v17, v4 offset:2304
    ds_read_b32 v18, v4 offset:2560
    ds_read_b32 v19, v4 offset:2816
    ds_read_b32 v20, v4 offset:3072
    ds_read_b32 v21, v4 offset:3328
    ds_read_b32 v22, v4 offset:3584
    ds_read_b32 v23, v4 offset:3840
    s_waitcnt lgkmcnt(0)
    v_add_f32 v16, v16, v17
    v_add_f32 v18, v18, v19
    v_add_f32 v20, v20, v21
    v_add_f32 v22, v22, v23
    v_add_f32 v16, v16, v18
    v_add_f32 v20, v20, v22
    v_add_f32 v16, v16, v20
    s_lshl_b32 s56, s91, 8
    v_add_u32 v4, s56, v7
    ds_write_b32 v4, v16 offset:10240
    s_waitcnt lgkmcnt(0)
    s_barrier
    s_cmp_lg_u32 s91, 0
    s_cbranch_scc1 L_w0_41
    ds_read_b32 v16, v7 offset:10240
    ds_read_b32 v17, v7 offset:10496
    ds_read_b32 v18, v7 offset:10752
    ds_read_b32 v19, v7 offset:11008
    s_waitcnt lgkmcnt(0)
    v_add_f32 v16, v16, v17
    v_add_f32 v18, v18, v19
    v_add_f32 v16, v16, v18
    v_cvt_pk_bf16_f32 v17, v16, v16
    v_and_b32 v16, s90, v17
    s_add_u32 s40, s30, 4194304
    s_addc_u32 s41, s31, 0
    s_mov_b32 s42, 10752
    s_mov_b32 s43, 0x20000
    s_lshl_b32 s56, s93, 8
    v_add_u32 v7, s56, v7
    buffer_store_dword v16, v7, s[40:43], 0 offen sc1
    s_waitcnt vmcnt(0)
L_w0_41:
    s_lshl_b32 s57, s93, 6
    s_cmp_lg_u32 s91, 0
    s_cbranch_scc1 L_w0_42
    s_add_u32 s56, s57, 36864
    v_mov_b32 v250, s56
    v_mov_b32 v252, s88
    v_mov_b32 v253, s89
    s_mov_b64 exec, 1
    buffer_store_dwordx2 v[252:253], v250, s[52:55], 0 offen sc1
    s_mov_b64 exec, -1
L_w0_42:
L_nomod_37:
    s_mul_i32 s70, s91, 24576
    s_add_u32 s70, s70, 60928
    v_lshrrev_b32 v200, 3, v1
    v_and_b32 v201, 7, v1
    v_and_b32 v208, 1, v3
    v_lshlrev_b32 v208, 1, v208
    v_xor_b32 v201, v201, v208
    v_lshlrev_b32 v201, 4, v201
    v_mul_u32_u24 v202, 3584, v200
    s_lshl_b32 s56, s96, 9
    s_lshl_b32 s57, s91, 7
    s_add_u32 s56, s56, s57
    v_add_u32 v202, s56, v202
    v_xor_b32 v208, 64, v201
    v_add_u32 v203, v202, v208
    v_add_u32 v202, v202, v201
    v_add_u32 v203, 27648, v203
    s_lshl_b32 s56, s95, 6
    s_lshl_b32 s57, s91, 4
    s_add_u32 s56, s56, s57
    s_mul_i32 s56, s56, 896
    v_lshrrev_b32 v208, 1, v200
    v_and_b32 v209, 7, v1
    v_xor_b32 v208, v208, v209
    v_lshlrev_b32 v208, 4, v208
    v_mul_u32_u24 v204, 896, v200
    v_add_u32 v204, s56, v204
    v_xor_b32 v209, 64, v208
    v_add_u32 v205, v204, v209
    v_add_u32 v205, 7168, v205
    v_add_u32 v204, v204, v208
    v_lshrrev_b32 v208, 1, v2
    v_xor_b32 v208, v208, v3
    v_lshlrev_b32 v208, 4, v208
    v_and_b32 v209, 7, v2
    v_lshl_add_u32 v208, v209, 7, v208
    v_lshrrev_b32 v209, 3, v2
    v_lshl_add_u32 v208, v209, 10, v208
    v_add_u32 v206, s70, v208
    v_xor_b32 v207, 64, v206
    s_mov_b32 s44, s4
    s_mov_b32 s45, s5
    s_mov_b32 s46, 1835008
    s_mov_b32 s47, 0x20000
    s_add_u32 m0, s70, 0
    s_movk_i32 s71, 0
    buffer_load_dwordx4 v204, s[44:47], s71 offen lds
    s_add_u32 m0, s70, 1024
    s_movk_i32 s71, 0
    buffer_load_dwordx4 v205, s[44:47], s71 offen lds
    s_add_u32 m0, s70, 2048
    s_movk_i32 s71, 128
    buffer_load_dwordx4 v204, s[44:47], s71 offen lds
    s_add_u32 m0, s70, 3072
    s_movk_i32 s71, 128
    buffer_load_dwordx4 v205, s[44:47], s71 offen lds
    s_add_u32 m0, s70, 4096
    s_movk_i32 s71, 256
    buffer_load_dwordx4 v204, s[44:47], s71 offen lds
    s_add_u32 m0, s70, 5120
    s_movk_i32 s71, 256
    buffer_load_dwordx4 v205, s[44:47], s71 offen lds
    s_add_u32 m0, s70, 6144
    s_movk_i32 s71, 384
    buffer_load_dwordx4 v204, s[44:47], s71 offen lds
    s_add_u32 m0, s70, 7168
    s_movk_i32 s71, 384
    buffer_load_dwordx4 v205, s[44:47], s71 offen lds
    s_add_u32 m0, s70, 8192
    s_movk_i32 s71, 512
    buffer_load_dwordx4 v204, s[44:47], s71 offen lds
    s_add_u32 m0, s70, 9216
    s_movk_i32 s71, 512
    buffer_load_dwordx4 v205, s[44:47], s71 offen lds
    s_add_u32 m0, s70, 10240
    s_movk_i32 s71, 640
    buffer_load_dwordx4 v204, s[44:47], s71 offen lds
    s_add_u32 m0, s70, 11264
    s_movk_i32 s71, 640
    buffer_load_dwordx4 v205, s[44:47], s71 offen lds
    s_add_u32 m0, s70, 12288
    s_movk_i32 s71, 768
    buffer_load_dwordx4 v204, s[44:47], s71 offen lds
    s_add_u32 m0, s70, 13312
    s_movk_i32 s71, 768
    buffer_load_dwordx4 v205, s[44:47], s71 offen lds
    v_add_u32 v204, 55296, v202
    v_add_u32 v205, 55296, v203
    s_cmp_eq_u32 s92, 7
    s_cselect_b32 s57, 27, 31
    v_min_u32 v244, s57, v1
    v_lshlrev_b32 v244, 3, v244
    v_add_u32 v244, s92, v244
    v_lshlrev_b32 v244, 6, v244
    v_add_u32 v244, 4096, v244
    s_cmp_lg_u32 s91, 0
    s_cbranch_scc1 L_w0_43
    buffer_load_dwordx2 v[240:241], v244, s[52:55], 0 offen sc1
L_w0_43:
    s_waitcnt vmcnt(0)
    s_cmp_lg_u32 s91, 0
    s_cbranch_scc1 L_w0_44
    s_or_b32 s59, s89, 15
    s_mov_b32 s58, s88
    s_mov_b32 s56, 0
    s_branch L_pxf_47
L_px_45:
    buffer_load_dwordx2 v[240:241], v244, s[52:55], 0 offen sc1
    s_waitcnt vmcnt(0)
L_pxf_47:
    v_or_b32 v243, 15, v241
    v_mov_b32 v242, v240
    v_cmp_ne_u64 vcc, s[58:59], v[242:243]
    s_cmp_eq_u64 vcc, 0
    s_cbranch_scc1 L_pxd_46
    s_add_u32 s56, s56, 1
    s_cmp_lt_u32 s56, 131072
    s_cbranch_scc1 L_px_45
L_pxd_46:
    v_and_b32 v241, 15, v241
    v_cmp_ne_u32 vcc, s97, v241
    s_cmp_eq_u64 vcc, 0
    s_cselect_b32 s57, 1, 0
    s_cmp_lt_u32 s56, 131072
    s_cselect_b32 s57, s57, 0
    s_mov_b32 s94, s57
    v_mov_b32 v240, s57
    v_mov_b32 v241, 163312
    ds_write_b32 v241, v240
    s_waitcnt lgkmcnt(0)
L_w0_44:
    s_mov_b32 s36, s18
    s_mov_b32 s37, s19
    s_mov_b32 s38, 1605632
    s_mov_b32 s39, 0x20000
    ds_read_b128 v[144:147], v206 offset:0
    ds_read_b128 v[148:151], v207 offset:0
    ds_read_b128 v[152:155], v206 offset:2048
    ds_read_b128 v[156:159], v207 offset:2048
    ds_read_b128 v[160:163], v206 offset:4096
    ds_read_b128 v[164:167], v207 offset:4096
    ds_read_b128 v[168:171], v206 offset:6144
    ds_read_b128 v[172:175], v207 offset:6144
    ds_read_b128 v[176:179], v206 offset:8192
    ds_read_b128 v[180:183], v207 offset:8192
    ds_read_b128 v[184:187], v206 offset:10240
    ds_read_b128 v[188:191], v207 offset:10240
    ds_read_b128 v[192:195], v206 offset:12288
    ds_read_b128 v[196:199], v207 offset:12288
    s_add_u32 m0, s70, 16384
    s_mov_b32 s71, 0
    buffer_load_dwordx4 v202, s[36:39], s71 offen offset:0 lds
    buffer_load_dwordx4 v203, s[36:39], s71 offen offset:1024 lds
    buffer_load_dwordx4 v204, s[36:39], s71 offen offset:2048 lds
    buffer_load_dwordx4 v205, s[36:39], s71 offen offset:3072 lds
    s_add_u32 m0, s70, 20480
    s_mov_b32 s71, 114688
    buffer_load_dwordx4 v202, s[36:39], s71 offen offset:0 lds
    buffer_load_dwordx4 v203, s[36:39], s71 offen offset:1024 lds
    buffer_load_dwordx4 v204, s[36:39], s71 offen offset:2048 lds
    buffer_load_dwordx4 v205, s[36:39], s71 offen offset:3072 lds
    s_waitcnt lgkmcnt(0)
    s_add_u32 m0, s70, 0
    s_mov_b32 s71, 229376
    buffer_load_dwordx4 v202, s[36:39], s71 offen offset:0 lds
    buffer_load_dwordx4 v203, s[36:39], s71 offen offset:1024 lds
    buffer_load_dwordx4 v204, s[36:39], s71 offen offset:2048 lds
    buffer_load_dwordx4 v205, s[36:39], s71 offen offset:3072 lds
    s_add_u32 m0, s70, 4096
    s_mov_b32 s71, 344064
    buffer_load_dwordx4 v202, s[36:39], s71 offen offset:0 lds
    buffer_load_dwordx4 v203, s[36:39], s71 offen offset:1024 lds
    buffer_load_dwordx4 v204, s[36:39], s71 offen offset:2048 lds
    buffer_load_dwordx4 v205, s[36:39], s71 offen offset:3072 lds
    s_add_u32 m0, s70, 8192
    s_mov_b32 s71, 458752
    buffer_load_dwordx4 v202, s[36:39], s71 offen offset:0 lds
    buffer_load_dwordx4 v203, s[36:39], s71 offen offset:1024 lds
    buffer_load_dwordx4 v204, s[36:39], s71 offen offset:2048 lds
    buffer_load_dwordx4 v205, s[36:39], s71 offen offset:3072 lds
    s_add_u32 m0, s70, 12288
    s_mov_b32 s71, 573440
    buffer_load_dwordx4 v202, s[36:39], s71 offen offset:0 lds
    buffer_load_dwordx4 v203, s[36:39], s71 offen offset:1024 lds
    buffer_load_dwordx4 v204, s[36:39], s71 offen offset:2048 lds
    buffer_load_dwordx4 v205, s[36:39], s71 offen offset:3072 lds
    v_min_u32 v245, 20, v1
    v_lshlrev_b32 v245, 6, v245
    v_add_u32 v245, 36864, v245
    s_cmp_lg_u32 s91, 0
    s_cbranch_scc1 L_w0_48
    buffer_load_dwordx2 v[246:247], v245, s[52:55], 0 offen sc1
L_w0_48:
    s_waitcnt vmcnt(0)
    v_lshrrev_b32 v22, 2, v2
    v_lshl_add_u32 v12, v3, 3, v22
    v_lshrrev_b32 v22, 1, v22
    v_and_b32 v23, 1, v3
    v_lshl_or_b32 v22, v23, 1, v22
    v_xor_b32 v22, 0, v22
    v_lshlrev_b32 v22, 5, v22
    v_lshl_add_u32 v12, v12, 7, v22
    v_and_b32 v22, 3, v2
    v_lshl_add_u32 v12, v22, 3, v12
    v_add_u32 v12, s70, v12
    v_lshrrev_b32 v22, 2, v2
    v_lshl_add_u32 v13, v3, 3, v22
    v_lshrrev_b32 v22, 1, v22
    v_and_b32 v23, 1, v3
    v_lshl_or_b32 v22, v23, 1, v22
    v_xor_b32 v22, 1, v22
    v_lshlrev_b32 v22, 5, v22
    v_lshl_add_u32 v13, v13, 7, v22
    v_and_b32 v22, 3, v2
    v_lshl_add_u32 v13, v22, 3, v13
    v_add_u32 v13, s70, v13
    v_lshrrev_b32 v22, 2, v2
    v_lshl_add_u32 v14, v3, 3, v22
    v_lshrrev_b32 v22, 1, v22
    v_and_b32 v23, 1, v3
    v_lshl_or_b32 v22, v23, 1, v22
    v_xor_b32 v22, 2, v22
    v_lshlrev_b32 v22, 5, v22
    v_lshl_add_u32 v14, v14, 7, v22
    v_and_b32 v22, 3, v2
    v_lshl_add_u32 v14, v22, 3, v14
    v_add_u32 v14, s70, v14
    v_lshrrev_b32 v22, 2, v2
    v_lshl_add_u32 v15, v3, 3, v22
    v_lshrrev_b32 v22, 1, v22
    v_and_b32 v23, 1, v3
    v_lshl_or_b32 v22, v23, 1, v22
    v_xor_b32 v22, 3, v22
    v_lshlrev_b32 v22, 5, v22
    v_lshl_add_u32 v15, v15, 7, v22
    v_and_b32 v22, 3, v2
    v_lshl_add_u32 v15, v22, 3, v15
    v_add_u32 v15, s70, v15
    v_mov_b32 v16, 0x3f803f80
    v_mov_b32 v17, v16
    v_mov_b32 v18, v16
    v_mov_b32 v19, v16
    v_and_b32 v20, 3, v0
    v_cmp_eq_u32 s[64:65], 1, v20
    v_cmp_eq_u32 s[66:67], 2, v20
    v_cmp_eq_u32 s[68:69], 3, v20
    v_lshrrev_b32 v20, 2, v2
    v_lshl_add_u32 v20, v20, 4, v2
    v_lshlrev_b32 v20, 2, v20
    v_mfma_f32_16x16x32_bf16 v[24:27], v[16:19], v[144:147], 0
    ds_read_b64_tr_b16 a[0:1], v12 offset:16384
    v_mfma_f32_16x16x32_bf16 v[28:31], v[144:147], v[144:147], 0
    ds_read_b64_tr_b16 a[2:3], v12 offset:16896
    v_mfma_f32_16x16x32_bf16 v[24:27], v[16:19], v[148:151], v[24:27]
    ds_read_b64_tr_b16 a[4:5], v13 offset:16384
    v_mfma_f32_16x16x32_bf16 v[28:31], v[148:151], v[148:151], v[28:31]
    ds_read_b64_tr_b16 a[6:7], v13 offset:16896
    v_mfma_f32_16x16x32_bf16 v[24:27], v[16:19], v[152:155], v[24:27]
    ds_read_b64_tr_b16 a[8:9], v14 offset:16384
    v_mfma_f32_16x16x32_bf16 v[28:31], v[152:155], v[152:155], v[28:31]
    ds_read_b64_tr_b16 a[10:11], v14 offset:16896
    v_mfma_f32_16x16x32_bf16 v[24:27], v[16:19], v[156:159], v[24:27]
    ds_read_b64_tr_b16 a[12:13], v15 offset:16384
    v_mfma_f32_16x16x32_bf16 v[28:31], v[156:159], v[156:159], v[28:31]
    ds_read_b64_tr_b16 a[14:15], v15 offset:16896
    v_mfma_f32_16x16x32_bf16 v[24:27], v[16:19], v[160:163], v[24:27]
    ds_read_b64_tr_b16 a[16:17], v12 offset:20480
    v_mfma_f32_16x16x32_bf16 v[28:31], v[160:163], v[160:163], v[28:31]
    ds_read_b64_tr_b16 a[18:19], v12 offset:20992
    v_mfma_f32_16x16x32_bf16 v[24:27], v[16:19], v[164:167], v[24:27]
    ds_read_b64_tr_b16 a[20:21], v13 offset:20480
    v_mfma_f32_16x16x32_bf16 v[28:31], v[164:167], v[164:167], v[28:31]
    ds_read_b64_tr_b16 a[22:23], v13 offset:20992
    v_mfma_f32_16x16x32_bf16 v[24:27], v[16:19], v[168:171], v[24:27]
    ds_read_b64_tr_b16 a[24:25], v14 offset:20480
    v_mfma_f32_16x16x32_bf16 v[28:31], v[168:171], v[168:171], v[28:31]
    ds_read_b64_tr_b16 a[26:27], v14 offset:20992
    v_mfma_f32_16x16x32_bf16 v[24:27], v[16:19], v[172:175], v[24:27]
    ds_read_b64_tr_b16 a[28:29], v15 offset:20480
    v_mfma_f32_16x16x32_bf16 v[28:31], v[172:175], v[172:175], v[28:31]
    ds_read_b64_tr_b16 a[30:31], v15 offset:20992
    v_mfma_f32_16x16x32_bf16 v[24:27], v[16:19], v[176:179], v[24:27]
    ds_read_b64_tr_b16 a[32:33], v12 offset:0
    v_mfma_f32_16x16x32_bf16 v[28:31], v[176:179], v[176:179], v[28:31]
    ds_read_b64_tr_b16 a[34:35], v12 offset:512
    v_mfma_f32_16x16x32_bf16 v[24:27], v[16:19], v[180:183], v[24:27]
    ds_read_b64_tr_b16 a[36:37], v13 offset:0
    v_mfma_f32_16x16x32_bf16 v[28:31], v[180:183], v[180:183], v[28:31]
    ds_read_b64_tr_b16 a[38:39], v13 offset:512
    v_mfma_f32_16x16x32_bf16 v[24:27], v[16:19], v[184:187], v[24:27]
    ds_read_b64_tr_b16 a[40:41], v14 offset:0
    v_mfma_f32_16x16x32_bf16 v[28:31], v[184:187], v[184:187], v[28:31]
    ds_read_b64_tr_b16 a[42:43], v14 offset:512
    v_mfma_f32_16x16x32_bf16 v[24:27], v[16:19], v[188:191], v[24:27]
    ds_read_b64_tr_b16 a[44:45], v15 offset:0
    v_mfma_f32_16x16x32_bf16 v[28:31], v[188:191], v[188:191], v[28:31]
    ds_read_b64_tr_b16 a[46:47], v15 offset:512
    v_mfma_f32_16x16x32_bf16 v[24:27], v[16:19], v[192:195], v[24:27]
    v_mfma_f32_16x16x32_bf16 v[28:31], v[192:195], v[192:195], v[28:31]
    v_mfma_f32_16x16x32_bf16 v[24:27], v[16:19], v[196:199], v[24:27]
    v_mfma_f32_16x16x32_bf16 v[28:31], v[196:199], v[196:199], v[28:31]
    s_nop 7
    v_cndmask_b32 v28, v28, v29, s[64:65]
    s_nop 6
    v_cndmask_b32 v28, v28, v30, s[66:67]
    s_nop 5
    v_cndmask_b32 v28, v28, v31, s[68:69]
    s_nop 4
    ds_bpermute_b32 v29, v20, v28
    s_waitcnt lgkmcnt(0)
    s_waitcnt lgkmcnt(0)
    s_nop 0
    v_mov_b32 v8, v24
    s_nop 0
    v_mov_b32 v10, v29
    v_mul_f32 v8, 0x3b124925, v8
    v_mul_f32 v10, 0x3b124925, v10
    v_fma_f32 v10, -v8, v8, v10
    v_max_f32 v10, 0, v10
    v_add_f32 v10, 0x3727c5ac, v10
    v_rsq_f32 v10, v10
    s_nop 0
    v_mul_f32_e64 v6, -v8, v10
    s_barrier
    v_mov_b32 v241, 163312
    ds_read_b32 v240, v241
    s_waitcnt lgkmcnt(0)
    v_readfirstlane_b32 s94, v240
L_win2:
    s_cmp_lg_u32 s91, 0
    s_cbranch_scc1 L_w0_49
    s_mov_b32 s56, 0
    s_branch L_fmf_51
L_fm_50:
    buffer_load_dwordx2 v[246:247], v245, s[52:55], 0 offen sc1
    s_waitcnt vmcnt(0)
L_fmf_51:
    v_cmp_ne_u64 vcc, s[88:89], v[246:247]
    s_cmp_eq_u64 vcc, 0
    s_cbranch_scc1 L_fmd_52
    s_add_u32 s56, s56, 1
    s_cmp_lt_u32 s56, 131072
    s_cbranch_scc1 L_fm_50
L_fmd_52:
L_w0_49:
    s_barrier
    s_add_u32 s40, s30, 4194304
    s_addc_u32 s41, s31, 0
    s_mov_b32 s42, 10752
    s_mov_b32 s43, 0x20000
    v_lshlrev_b32 v4, 4, v0
    s_movk_i32 s56, 0
    buffer_load_dwordx4 v[208:211], v4, s[40:43], s56 offen sc1
    s_movk_i32 s56, 1792
    buffer_load_dwordx4 v[212:215], v4, s[40:43], s56 offen sc1
    s_movk_i32 s56, 3584
    buffer_load_dwordx4 v[216:219], v4, s[40:43], s56 offen sc1
    ds_read_b64_tr_b16 a[48:49], v12 offset:4096
    ds_read_b64_tr_b16 a[50:51], v12 offset:4608
    ds_read_b64_tr_b16 a[52:53], v13 offset:4096
    ds_read_b64_tr_b16 a[54:55], v13 offset:4608
    ds_read_b64_tr_b16 a[56:57], v14 offset:4096
    ds_read_b64_tr_b16 a[58:59], v14 offset:4608
    ds_read_b64_tr_b16 a[60:61], v15 offset:4096
    ds_read_b64_tr_b16 a[62:63], v15 offset:4608
    s_add_u32 m0, s70, 16384
    s_mov_b32 s71, 688128
    buffer_load_dwordx4 v202, s[36:39], s71 offen offset:0 lds
    buffer_load_dwordx4 v203, s[36:39], s71 offen offset:1024 lds
    buffer_load_dwordx4 v204, s[36:39], s71 offen offset:2048 lds
    buffer_load_dwordx4 v205, s[36:39], s71 offen offset:3072 lds
    ds_read_b64_tr_b16 a[64:65], v12 offset:8192
    ds_read_b64_tr_b16 a[66:67], v12 offset:8704
    ds_read_b64_tr_b16 a[68:69], v13 offset:8192
    ds_read_b64_tr_b16 a[70:71], v13 offset:8704
    ds_read_b64_tr_b16 a[72:73], v14 offset:8192
    ds_read_b64_tr_b16 a[74:75], v14 offset:8704
    ds_read_b64_tr_b16 a[76:77], v15 offset:8192
    ds_read_b64_tr_b16 a[78:79], v15 offset:8704
    s_add_u32 m0, s70, 20480
    s_mov_b32 s71, 802816
    buffer_load_dwordx4 v202, s[36:39], s71 offen offset:0 lds
    buffer_load_dwordx4 v203, s[36:39], s71 offen offset:1024 lds
    buffer_load_dwordx4 v204, s[36:39], s71 offen offset:2048 lds
    buffer_load_dwordx4 v205, s[36:39], s71 offen offset:3072 lds
    ds_read_b64_tr_b16 a[80:81], v12 offset:12288
    ds_read_b64_tr_b16 a[82:83], v12 offset:12800
    ds_read_b64_tr_b16 a[84:85], v13 offset:12288
    ds_read_b64_tr_b16 a[86:87], v13 offset:12800
    ds_read_b64_tr_b16 a[88:89], v14 offset:12288
    ds_read_b64_tr_b16 a[90:91], v14 offset:12800
    ds_read_b64_tr_b16 a[92:93], v15 offset:12288
    ds_read_b64_tr_b16 a[94:95], v15 offset:12800
    s_lshl_b32 s56, s95, 7
    v_lshlrev_b32 v9, 12, v200
    v_add_u32 v9, s56, v9
    v_xor_b32 v11, 64, v201
    v_add_u32 v11, v9, v11
    v_add_u32 v9, v9, v201
    v_add_u32 v24, 63488, v9
    v_add_u32 v11, 31744, v11
    v_add_u32 v25, 63488, v11
    s_add_u32 s56, s96, 0
    s_cmp_ge_u32 s56, 7
    s_cselect_b32 s57, 7, 0
    s_sub_u32 s56, s56, s57
    s_lshl_b32 s56, s56, 3
    s_lshl_b32 s57, s91, 1
    s_add_u32 s6, s56, s57
    s_add_u32 s56, s96, 1
    s_cmp_ge_u32 s56, 7
    s_cselect_b32 s57, 7, 0
    s_sub_u32 s56, s56, s57
    s_lshl_b32 s56, s56, 3
    s_lshl_b32 s57, s91, 1
    s_add_u32 s7, s56, s57
    s_add_u32 s56, s96, 2
    s_cmp_ge_u32 s56, 7
    s_cselect_b32 s57, 7, 0
    s_sub_u32 s56, s56, s57
    s_lshl_b32 s56, s56, 3
    s_lshl_b32 s57, s91, 1
    s_add_u32 s8, s56, s57
    s_add_u32 s56, s96, 3
    s_cmp_ge_u32 s56, 7
    s_cselect_b32 s57, 7, 0
    s_sub_u32 s56, s56, s57
    s_lshl_b32 s56, s56, 3
    s_lshl_b32 s57, s91, 1
    s_add_u32 s9, s56, s57
    s_add_u32 s56, s96, 4
    s_cmp_ge_u32 s56, 7
    s_cselect_b32 s57, 7, 0
    s_sub_u32 s56, s56, s57
    s_lshl_b32 s56, s56, 3
    s_lshl_b32 s57, s91, 1
    s_add_u32 s10, s56, s57
    s_add_u32 s56, s96, 5
    s_cmp_ge_u32 s56, 7
    s_cselect_b32 s57, 7, 0
    s_sub_u32 s56, s56, s57
    s_lshl_b32 s56, s56, 3
    s_lshl_b32 s57, s91, 1
    s_add_u32 s11, s56, s57
    s_add_u32 s56, s96, 6
    s_cmp_ge_u32 s56, 7
    s_cselect_b32 s57, 7, 0
    s_sub_u32 s56, s56, s57
    s_lshl_b32 s56, s56, 3
    s_lshl_b32 s57, s91, 1
    s_add_u32 s12, s56, s57
    s_mul_i32 s63, s91, 14336
    v_lshrrev_b32 v232, 2, v2
    v_lshl_add_u32 v22, v3, 3, v232
    v_lshrrev_b32 v232, 1, v232
    v_and_b32 v233, 1, v3
    v_lshl_or_b32 v232, v233, 1, v232
    v_xor_b32 v232, s91, v232
    v_lshlrev_b32 v232, 5, v232
    v_lshl_add_u32 v22, v22, 7, v232
    v_and_b32 v232, 3, v2
    v_lshl_add_u32 v22, v232, 3, v22
    s_waitcnt vmcnt(8)
    v_add_f32 v212, 1.0, v212
    v_add_f32 v213, 1.0, v213
    v_add_f32 v214, 1.0, v214
    v_add_f32 v215, 1.0, v215
    v_pk_mul_f32 v[212:213], v[212:213], v[216:217]
    v_pk_mul_f32 v[208:209], v[208:209], v[216:217]
    v_pk_mul_f32 v[214:215], v[214:215], v[218:219]
    v_pk_mul_f32 v[210:211], v[210:211], v[218:219]
    v_cmp_gt_u32 vcc, 112, v0
    s_and_saveexec_b64 s[58:59], vcc
    ds_write_b128 v4, v[212:215] offset:0
    ds_write_b128 v4, v[208:211] offset:1792
    s_mov_b64 exec, s[58:59]
    s_waitcnt lgkmcnt(0)
    s_barrier
    v_lshlrev_b32 v21, 5, v3
    v_lshl_add_u32 v21, v2, 7, v21
    ds_read_b128 v[208:211], v21 offset:0
    ds_read_b128 v[212:215], v21 offset:16
    ds_read_b128 v[216:219], v21 offset:1792
    ds_read_b128 v[220:223], v21 offset:1808
    s_waitcnt lgkmcnt(0)
    v_lshlrev_b32 v224, 16, v144
    v_and_b32 v225, s90, v144
    s_add_u32 m0, s70, 0
    s_mov_b32 s71, 917504
    buffer_load_dwordx4 v202, s[36:39], s71 offen offset:0 lds
    v_lshlrev_b32 v226, 16, v145
    v_and_b32 v227, s90, v145
    v_lshlrev_b32 v228, 16, v146
    v_and_b32 v229, s90, v146
    v_lshlrev_b32 v230, 16, v147
    v_and_b32 v231, s90, v147
    v_mov_b32_dpp v32, v216 row_newbcast:0 row_mask:0xf bank_mask:0xf
    v_mov_b32_dpp v33, v217 row_newbcast:0 row_mask:0xf bank_mask:0xf
    v_mov_b32_dpp v34, v218 row_newbcast:0 row_mask:0xf bank_mask:0xf
    v_mov_b32_dpp v35, v219 row_newbcast:0 row_mask:0xf bank_mask:0xf
    v_mov_b32_dpp v36, v220 row_newbcast:0 row_mask:0xf bank_mask:0xf
    v_mov_b32_dpp v37, v221 row_newbcast:0 row_mask:0xf bank_mask:0xf
    v_mov_b32_dpp v38, v222 row_newbcast:0 row_mask:0xf bank_mask:0xf
    buffer_load_dwordx4 v203, s[36:39], s71 offen offset:1024 lds
    v_mov_b32_dpp v39, v223 row_newbcast:0 row_mask:0xf bank_mask:0xf
    v_pk_fma_f32 v[224:225], v[224:225], v[10:11], v[6:7] op_sel_hi:[1,0,0]
    v_pk_fma_f32 v[226:227], v[226:227], v[10:11], v[6:7] op_sel_hi:[1,0,0]
    v_pk_fma_f32 v[228:229], v[228:229], v[10:11], v[6:7] op_sel_hi:[1,0,0]
    v_pk_fma_f32 v[230:231], v[230:231], v[10:11], v[6:7] op_sel_hi:[1,0,0]
    v_fmac_f32_dpp v32, v208, v224 row_newbcast:0 row_mask:0xf bank_mask:0xf
    v_fmac_f32_dpp v33, v209, v225 row_newbcast:0 row_mask:0xf bank_mask:0xf
    v_fmac_f32_dpp v34, v210, v226 row_newbcast:0 row_mask:0xf bank_mask:0xf
    v_fmac_f32_dpp v35, v211, v227 row_newbcast:0 row_mask:0xf bank_mask:0xf
    v_fmac_f32_dpp v36, v212, v228 row_newbcast:0 row_mask:0xf bank_mask:0xf
    v_fmac_f32_dpp v37, v213, v229 row_newbcast:0 row_mask:0xf bank_mask:0xf
    v_fmac_f32_dpp v38, v214, v230 row_newbcast:0 row_mask:0xf bank_mask:0xf
    v_fmac_f32_dpp v39, v215, v231 row_newbcast:0 row_mask:0xf bank_mask:0xf
    s_waitcnt vmcnt(6)
    v_lshlrev_b32 v224, 16, v148
    v_and_b32 v225, s90, v148
    ds_read_b64_tr_b16 a[96:97], v12 offset:16384
    v_lshlrev_b32 v226, 16, v149
    v_and_b32 v227, s90, v149
    ds_read_b64_tr_b16 a[98:99], v12 offset:16896
    v_lshlrev_b32 v228, 16, v150
    v_and_b32 v229, s90, v150
    v_lshlrev_b32 v230, 16, v151
    ds_read_b64_tr_b16 a[100:101], v13 offset:16384
    v_and_b32 v231, s90, v151
    v_mov_b32_dpp v40, v216 row_newbcast:1 row_mask:0xf bank_mask:0xf
    ds_read_b64_tr_b16 a[102:103], v13 offset:16896
    v_mov_b32_dpp v41, v217 row_newbcast:1 row_mask:0xf bank_mask:0xf
    v_mov_b32_dpp v42, v218 row_newbcast:1 row_mask:0xf bank_mask:0xf
    v_mov_b32_dpp v43, v219 row_newbcast:1 row_mask:0xf bank_mask:0xf
    buffer_load_dwordx4 v204, s[36:39], s71 offen offset:2048 lds
    v_mov_b32_dpp v44, v220 row_newbcast:1 row_mask:0xf bank_mask:0xf
    v_mov_b32_dpp v45, v221 row_newbcast:1 row_mask:0xf bank_mask:0xf
    v_mov_b32_dpp v46, v222 row_newbcast:1 row_mask:0xf bank_mask:0xf
    ds_read_b64_tr_b16 a[104:105], v14 offset:16384
    v_mov_b32_dpp v47, v223 row_newbcast:1 row_mask:0xf bank_mask:0xf
    v_pk_fma_f32 v[224:225], v[224:225], v[10:11], v[6:7] op_sel_hi:[1,0,0]
    ds_read_b64_tr_b16 a[106:107], v14 offset:16896
    v_pk_fma_f32 v[226:227], v[226:227], v[10:11], v[6:7] op_sel_hi:[1,0,0]
    v_pk_fma_f32 v[228:229], v[228:229], v[10:11], v[6:7] op_sel_hi:[1,0,0]
    v_pk_fma_f32 v[230:231], v[230:231], v[10:11], v[6:7] op_sel_hi:[1,0,0]
    ds_read_b64_tr_b16 a[108:109], v15 offset:16384
    v_fmac_f32_dpp v40, v208, v224 row_newbcast:1 row_mask:0xf bank_mask:0xf
    v_fmac_f32_dpp v41, v209, v225 row_newbcast:1 row_mask:0xf bank_mask:0xf
    ds_read_b64_tr_b16 a[110:111], v15 offset:16896
    v_fmac_f32_dpp v42, v210, v226 row_newbcast:1 row_mask:0xf bank_mask:0xf
    v_fmac_f32_dpp v43, v211, v227 row_newbcast:1 row_mask:0xf bank_mask:0xf
    v_fmac_f32_dpp v44, v212, v228 row_newbcast:1 row_mask:0xf bank_mask:0xf
    buffer_load_dwordx4 v205, s[36:39], s71 offen offset:3072 lds
    v_fmac_f32_dpp v45, v213, v229 row_newbcast:1 row_mask:0xf bank_mask:0xf
    v_fmac_f32_dpp v46, v214, v230 row_newbcast:1 row_mask:0xf bank_mask:0xf
    v_fmac_f32_dpp v47, v215, v231 row_newbcast:1 row_mask:0xf bank_mask:0xf
    v_lshlrev_b32 v224, 16, v152
    v_and_b32 v225, s90, v152
    s_add_u32 m0, s70, 4096
    s_mov_b32 s71, 1032192
    buffer_load_dwordx4 v202, s[36:39], s71 offen offset:0 lds
    v_lshlrev_b32 v226, 16, v153
    v_and_b32 v227, s90, v153
    v_lshlrev_b32 v228, 16, v154
    v_and_b32 v229, s90, v154
    v_lshlrev_b32 v230, 16, v155
    v_and_b32 v231, s90, v155
    v_mov_b32_dpp v48, v216 row_newbcast:2 row_mask:0xf bank_mask:0xf
    v_mov_b32_dpp v49, v217 row_newbcast:2 row_mask:0xf bank_mask:0xf
    v_mov_b32_dpp v50, v218 row_newbcast:2 row_mask:0xf bank_mask:0xf
    v_mov_b32_dpp v51, v219 row_newbcast:2 row_mask:0xf bank_mask:0xf
    v_mov_b32_dpp v52, v220 row_newbcast:2 row_mask:0xf bank_mask:0xf
    v_mov_b32_dpp v53, v221 row_newbcast:2 row_mask:0xf bank_mask:0xf
    v_mov_b32_dpp v54, v222 row_newbcast:2 row_mask:0xf bank_mask:0xf
    buffer_load_dwordx4 v203, s[36:39], s71 offen offset:1024 lds
    v_mov_b32_dpp v55, v223 row_newbcast:2 row_mask:0xf bank_mask:0xf
    v_pk_fma_f32 v[224:225], v[224:225], v[10:11], v[6:7] op_sel_hi:[1,0,0]
    v_pk_fma_f32 v[226:227], v[226:227], v[10:11], v[6:7] op_sel_hi:[1,0,0]
    v_pk_fma_f32 v[228:229], v[228:229], v[10:11], v[6:7] op_sel_hi:[1,0,0]
    v_pk_fma_f32 v[230:231], v[230:231], v[10:11], v[6:7] op_sel_hi:[1,0,0]
    v_fmac_f32_dpp v48, v208, v224 row_newbcast:2 row_mask:0xf bank_mask:0xf
    v_fmac_f32_dpp v49, v209, v225 row_newbcast:2 row_mask:0xf bank_mask:0xf
    v_fmac_f32_dpp v50, v210, v226 row_newbcast:2 row_mask:0xf bank_mask:0xf
    v_fmac_f32_dpp v51, v211, v227 row_newbcast:2 row_mask:0xf bank_mask:0xf
    v_fmac_f32_dpp v52, v212, v228 row_newbcast:2 row_mask:0xf bank_mask:0xf
    v_fmac_f32_dpp v53, v213, v229 row_newbcast:2 row_mask:0xf bank_mask:0xf
    v_fmac_f32_dpp v54, v214, v230 row_newbcast:2 row_mask:0xf bank_mask:0xf
    v_fmac_f32_dpp v55, v215, v231 row_newbcast:2 row_mask:0xf bank_mask:0xf
    v_lshlrev_b32 v224, 16, v156
    v_and_b32 v225, s90, v156
    buffer_load_dwordx4 v204, s[36:39], s71 offen offset:2048 lds
    v_lshlrev_b32 v226, 16, v157
    v_and_b32 v227, s90, v157
    v_lshlrev_b32 v228, 16, v158
    v_and_b32 v229, s90, v158
    v_lshlrev_b32 v230, 16, v159
    v_and_b32 v231, s90, v159
    v_mov_b32_dpp v56, v216 row_newbcast:3 row_mask:0xf bank_mask:0xf
    v_mov_b32_dpp v57, v217 row_newbcast:3 row_mask:0xf bank_mask:0xf
    v_mov_b32_dpp v58, v218 row_newbcast:3 row_mask:0xf bank_mask:0xf
    v_mov_b32_dpp v59, v219 row_newbcast:3 row_mask:0xf bank_mask:0xf
    v_mov_b32_dpp v60, v220 row_newbcast:3 row_mask:0xf bank_mask:0xf
    v_mov_b32_dpp v61, v221 row_newbcast:3 row_mask:0xf bank_mask:0xf
    v_mov_b32_dpp v62, v222 row_newbcast:3 row_mask:0xf bank_mask:0xf
    buffer_load_dwordx4 v205, s[36:39], s71 offen offset:3072 lds
    v_mov_b32_dpp v63, v223 row_newbcast:3 row_mask:0xf bank_mask:0xf
    v_pk_fma_f32 v[224:225], v[224:225], v[10:11], v[6:7] op_sel_hi:[1,0,0]
    v_pk_fma_f32 v[226:227], v[226:227], v[10:11], v[6:7] op_sel_hi:[1,0,0]
    v_pk_fma_f32 v[228:229], v[228:229], v[10:11], v[6:7] op_sel_hi:[1,0,0]
    v_pk_fma_f32 v[230:231], v[230:231], v[10:11], v[6:7] op_sel_hi:[1,0,0]
    v_fmac_f32_dpp v56, v208, v224 row_newbcast:3 row_mask:0xf bank_mask:0xf
    v_fmac_f32_dpp v57, v209, v225 row_newbcast:3 row_mask:0xf bank_mask:0xf
    v_fmac_f32_dpp v58, v210, v226 row_newbcast:3 row_mask:0xf bank_mask:0xf
    v_fmac_f32_dpp v59, v211, v227 row_newbcast:3 row_mask:0xf bank_mask:0xf
    v_fmac_f32_dpp v60, v212, v228 row_newbcast:3 row_mask:0xf bank_mask:0xf
    v_fmac_f32_dpp v61, v213, v229 row_newbcast:3 row_mask:0xf bank_mask:0xf
    v_fmac_f32_dpp v62, v214, v230 row_newbcast:3 row_mask:0xf bank_mask:0xf
    v_fmac_f32_dpp v63, v215, v231 row_newbcast:3 row_mask:0xf bank_mask:0xf
    s_waitcnt vmcnt(8)
    v_lshlrev_b32 v224, 16, v160
    v_and_b32 v225, s90, v160
    ds_read_b64_tr_b16 a[112:113], v12 offset:20480
    v_lshlrev_b32 v226, 16, v161
    v_and_b32 v227, s90, v161
    ds_read_b64_tr_b16 a[114:115], v12 offset:20992
    v_lshlrev_b32 v228, 16, v162
    v_and_b32 v229, s90, v162
    v_lshlrev_b32 v230, 16, v163
    ds_read_b64_tr_b16 a[116:117], v13 offset:20480
    v_and_b32 v231, s90, v163
    v_mov_b32_dpp v64, v216 row_newbcast:4 row_mask:0xf bank_mask:0xf
    ds_read_b64_tr_b16 a[118:119], v13 offset:20992
    v_mov_b32_dpp v65, v217 row_newbcast:4 row_mask:0xf bank_mask:0xf
    v_mov_b32_dpp v66, v218 row_newbcast:4 row_mask:0xf bank_mask:0xf
    v_mov_b32_dpp v67, v219 row_newbcast:4 row_mask:0xf bank_mask:0xf
    s_add_u32 m0, s70, 8192
    s_mov_b32 s71, 1146880
    buffer_load_dwordx4 v202, s[36:39], s71 offen offset:0 lds
    v_mov_b32_dpp v68, v220 row_newbcast:4 row_mask:0xf bank_mask:0xf
    v_mov_b32_dpp v69, v221 row_newbcast:4 row_mask:0xf bank_mask:0xf
    v_mov_b32_dpp v70, v222 row_newbcast:4 row_mask:0xf bank_mask:0xf
    ds_read_b64_tr_b16 a[120:121], v14 offset:20480
    v_mov_b32_dpp v71, v223 row_newbcast:4 row_mask:0xf bank_mask:0xf
    v_pk_fma_f32 v[224:225], v[224:225], v[10:11], v[6:7] op_sel_hi:[1,0,0]
    ds_read_b64_tr_b16 a[122:123], v14 offset:20992
    v_pk_fma_f32 v[226:227], v[226:227], v[10:11], v[6:7] op_sel_hi:[1,0,0]
    v_pk_fma_f32 v[228:229], v[228:229], v[10:11], v[6:7] op_sel_hi:[1,0,0]
    v_pk_fma_f32 v[230:231], v[230:231], v[10:11], v[6:7] op_sel_hi:[1,0,0]
    ds_read_b64_tr_b16 a[124:125], v15 offset:20480
    v_fmac_f32_dpp v64, v208, v224 row_newbcast:4 row_mask:0xf bank_mask:0xf
    v_fmac_f32_dpp v65, v209, v225 row_newbcast:4 row_mask:0xf bank_mask:0xf
    ds_read_b64_tr_b16 a[126:127], v15 offset:20992
    v_fmac_f32_dpp v66, v210, v226 row_newbcast:4 row_mask:0xf bank_mask:0xf
    v_fmac_f32_dpp v67, v211, v227 row_newbcast:4 row_mask:0xf bank_mask:0xf
    v_fmac_f32_dpp v68, v212, v228 row_newbcast:4 row_mask:0xf bank_mask:0xf
    buffer_load_dwordx4 v203, s[36:39], s71 offen offset:1024 lds
    v_fmac_f32_dpp v69, v213, v229 row_newbcast:4 row_mask:0xf bank_mask:0xf
    v_fmac_f32_dpp v70, v214, v230 row_newbcast:4 row_mask:0xf bank_mask:0xf
    v_fmac_f32_dpp v71, v215, v231 row_newbcast:4 row_mask:0xf bank_mask:0xf
    v_lshlrev_b32 v224, 16, v164
    v_and_b32 v225, s90, v164
    buffer_load_dwordx4 v204, s[36:39], s71 offen offset:2048 lds
    v_lshlrev_b32 v226, 16, v165
    v_and_b32 v227, s90, v165
    v_lshlrev_b32 v228, 16, v166
    v_and_b32 v229, s90, v166
    v_lshlrev_b32 v230, 16, v167
    v_and_b32 v231, s90, v167
    v_mov_b32_dpp v72, v216 row_newbcast:5 row_mask:0xf bank_mask:0xf
    v_mov_b32_dpp v73, v217 row_newbcast:5 row_mask:0xf bank_mask:0xf
    v_mov_b32_dpp v74, v218 row_newbcast:5 row_mask:0xf bank_mask:0xf
    v_mov_b32_dpp v75, v219 row_newbcast:5 row_mask:0xf bank_mask:0xf
    v_mov_b32_dpp v76, v220 row_newbcast:5 row_mask:0xf bank_mask:0xf
    v_mov_b32_dpp v77, v221 row_newbcast:5 row_mask:0xf bank_mask:0xf
    v_mov_b32_dpp v78, v222 row_newbcast:5 row_mask:0xf bank_mask:0xf
    buffer_load_dwordx4 v205, s[36:39], s71 offen offset:3072 lds
    v_mov_b32_dpp v79, v223 row_newbcast:5 row_mask:0xf bank_mask:0xf
    v_pk_fma_f32 v[224:225], v[224:225], v[10:11], v[6:7] op_sel_hi:[1,0,0]
    v_pk_fma_f32 v[226:227], v[226:227], v[10:11], v[6:7] op_sel_hi:[1,0,0]
    v_pk_fma_f32 v[228:229], v[228:229], v[10:11], v[6:7] op_sel_hi:[1,0,0]
    v_pk_fma_f32 v[230:231], v[230:231], v[10:11], v[6:7] op_sel_hi:[1,0,0]
    v_fmac_f32_dpp v72, v208, v224 row_newbcast:5 row_mask:0xf bank_mask:0xf
    v_fmac_f32_dpp v73, v209, v225 row_newbcast:5 row_mask:0xf bank_mask:0xf
    v_fmac_f32_dpp v74, v210, v226 row_newbcast:5 row_mask:0xf bank_mask:0xf
    v_fmac_f32_dpp v75, v211, v227 row_newbcast:5 row_mask:0xf bank_mask:0xf
    v_fmac_f32_dpp v76, v212, v228 row_newbcast:5 row_mask:0xf bank_mask:0xf
    v_fmac_f32_dpp v77, v213, v229 row_newbcast:5 row_mask:0xf bank_mask:0xf
    v_fmac_f32_dpp v78, v214, v230 row_newbcast:5 row_mask:0xf bank_mask:0xf
    v_fmac_f32_dpp v79, v215, v231 row_newbcast:5 row_mask:0xf bank_mask:0xf
    v_lshlrev_b32 v224, 16, v168
    v_and_b32 v225, s90, v168
    s_add_u32 m0, s70, 12288
    s_mov_b32 s71, 1261568
    buffer_load_dwordx4 v202, s[36:39], s71 offen offset:0 lds
    v_lshlrev_b32 v226, 16, v169
    v_and_b32 v227, s90, v169
    v_lshlrev_b32 v228, 16, v170
    v_and_b32 v229, s90, v170
    v_lshlrev_b32 v230, 16, v171
    v_and_b32 v231, s90, v171
    v_mov_b32_dpp v80, v216 row_newbcast:6 row_mask:0xf bank_mask:0xf
    v_mov_b32_dpp v81, v217 row_newbcast:6 row_mask:0xf bank_mask:0xf
    v_mov_b32_dpp v82, v218 row_newbcast:6 row_mask:0xf bank_mask:0xf
    v_mov_b32_dpp v83, v219 row_newbcast:6 row_mask:0xf bank_mask:0xf
    v_mov_b32_dpp v84, v220 row_newbcast:6 row_mask:0xf bank_mask:0xf
    v_mov_b32_dpp v85, v221 row_newbcast:6 row_mask:0xf bank_mask:0xf
    v_mov_b32_dpp v86, v222 row_newbcast:6 row_mask:0xf bank_mask:0xf
    buffer_load_dwordx4 v203, s[36:39], s71 offen offset:1024 lds
    v_mov_b32_dpp v87, v223 row_newbcast:6 row_mask:0xf bank_mask:0xf
    v_pk_fma_f32 v[224:225], v[224:225], v[10:11], v[6:7] op_sel_hi:[1,0,0]
    v_pk_fma_f32 v[226:227], v[226:227], v[10:11], v[6:7] op_sel_hi:[1,0,0]
    v_pk_fma_f32 v[228:229], v[228:229], v[10:11], v[6:7] op_sel_hi:[1,0,0]
    v_pk_fma_f32 v[230:231], v[230:231], v[10:11], v[6:7] op_sel_hi:[1,0,0]
    v_fmac_f32_dpp v80, v208, v224 row_newbcast:6 row_mask:0xf bank_mask:0xf
    v_fmac_f32_dpp v81, v209, v225 row_newbcast:6 row_mask:0xf bank_mask:0xf
    v_fmac_f32_dpp v82, v210, v226 row_newbcast:6 row_mask:0xf bank_mask:0xf
    v_fmac_f32_dpp v83, v211, v227 row_newbcast:6 row_mask:0xf bank_mask:0xf
    v_fmac_f32_dpp v84, v212, v228 row_newbcast:6 row_mask:0xf bank_mask:0xf
    v_fmac_f32_dpp v85, v213, v229 row_newbcast:6 row_mask:0xf bank_mask:0xf
    v_fmac_f32_dpp v86, v214, v230 row_newbcast:6 row_mask:0xf bank_mask:0xf
    v_fmac_f32_dpp v87, v215, v231 row_newbcast:6 row_mask:0xf bank_mask:0xf
    v_lshlrev_b32 v224, 16, v172
    v_and_b32 v225, s90, v172
    buffer_load_dwordx4 v204, s[36:39], s71 offen offset:2048 lds
    v_lshlrev_b32 v226, 16, v173
    v_and_b32 v227, s90, v173
    v_lshlrev_b32 v228, 16, v174
    v_and_b32 v229, s90, v174
    v_lshlrev_b32 v230, 16, v175
    v_and_b32 v231, s90, v175
    v_mov_b32_dpp v88, v216 row_newbcast:7 row_mask:0xf bank_mask:0xf
    v_mov_b32_dpp v89, v217 row_newbcast:7 row_mask:0xf bank_mask:0xf
    v_mov_b32_dpp v90, v218 row_newbcast:7 row_mask:0xf bank_mask:0xf
    v_mov_b32_dpp v91, v219 row_newbcast:7 row_mask:0xf bank_mask:0xf
    v_mov_b32_dpp v92, v220 row_newbcast:7 row_mask:0xf bank_mask:0xf
    v_mov_b32_dpp v93, v221 row_newbcast:7 row_mask:0xf bank_mask:0xf
    v_mov_b32_dpp v94, v222 row_newbcast:7 row_mask:0xf bank_mask:0xf
    buffer_load_dwordx4 v205, s[36:39], s71 offen offset:3072 lds
    v_mov_b32_dpp v95, v223 row_newbcast:7 row_mask:0xf bank_mask:0xf
    v_pk_fma_f32 v[224:225], v[224:225], v[10:11], v[6:7] op_sel_hi:[1,0,0]
    v_pk_fma_f32 v[226:227], v[226:227], v[10:11], v[6:7] op_sel_hi:[1,0,0]
    v_pk_fma_f32 v[228:229], v[228:229], v[10:11], v[6:7] op_sel_hi:[1,0,0]
    v_pk_fma_f32 v[230:231], v[230:231], v[10:11], v[6:7] op_sel_hi:[1,0,0]
    v_fmac_f32_dpp v88, v208, v224 row_newbcast:7 row_mask:0xf bank_mask:0xf
    v_fmac_f32_dpp v89, v209, v225 row_newbcast:7 row_mask:0xf bank_mask:0xf
    v_fmac_f32_dpp v90, v210, v226 row_newbcast:7 row_mask:0xf bank_mask:0xf
    v_fmac_f32_dpp v91, v211, v227 row_newbcast:7 row_mask:0xf bank_mask:0xf
    v_fmac_f32_dpp v92, v212, v228 row_newbcast:7 row_mask:0xf bank_mask:0xf
    v_fmac_f32_dpp v93, v213, v229 row_newbcast:7 row_mask:0xf bank_mask:0xf
    v_fmac_f32_dpp v94, v214, v230 row_newbcast:7 row_mask:0xf bank_mask:0xf
    v_fmac_f32_dpp v95, v215, v231 row_newbcast:7 row_mask:0xf bank_mask:0xf
    s_waitcnt lgkmcnt(8)
    v_lshlrev_b32 v224, 16, v176
    v_and_b32 v225, s90, v176
    s_add_u32 m0, s70, 16384
    s_mov_b32 s71, 1376256
    buffer_load_dwordx4 v202, s[36:39], s71 offen offset:0 lds
    v_lshlrev_b32 v226, 16, v177
    v_and_b32 v227, s90, v177
    v_lshlrev_b32 v228, 16, v178
    v_and_b32 v229, s90, v178
    v_lshlrev_b32 v230, 16, v179
    v_and_b32 v231, s90, v179
    v_mov_b32_dpp v96, v216 row_newbcast:8 row_mask:0xf bank_mask:0xf
    v_mov_b32_dpp v97, v217 row_newbcast:8 row_mask:0xf bank_mask:0xf
    v_mov_b32_dpp v98, v218 row_newbcast:8 row_mask:0xf bank_mask:0xf
    v_mov_b32_dpp v99, v219 row_newbcast:8 row_mask:0xf bank_mask:0xf
    v_mov_b32_dpp v100, v220 row_newbcast:8 row_mask:0xf bank_mask:0xf
    v_mov_b32_dpp v101, v221 row_newbcast:8 row_mask:0xf bank_mask:0xf
    v_mov_b32_dpp v102, v222 row_newbcast:8 row_mask:0xf bank_mask:0xf
    buffer_load_dwordx4 v203, s[36:39], s71 offen offset:1024 lds
    v_mov_b32_dpp v103, v223 row_newbcast:8 row_mask:0xf bank_mask:0xf
    v_pk_fma_f32 v[224:225], v[224:225], v[10:11], v[6:7] op_sel_hi:[1,0,0]
    v_pk_fma_f32 v[226:227], v[226:227], v[10:11], v[6:7] op_sel_hi:[1,0,0]
    v_pk_fma_f32 v[228:229], v[228:229], v[10:11], v[6:7] op_sel_hi:[1,0,0]
    v_pk_fma_f32 v[230:231], v[230:231], v[10:11], v[6:7] op_sel_hi:[1,0,0]
    v_fmac_f32_dpp v96, v208, v224 row_newbcast:8 row_mask:0xf bank_mask:0xf
    v_fmac_f32_dpp v97, v209, v225 row_newbcast:8 row_mask:0xf bank_mask:0xf
    v_fmac_f32_dpp v98, v210, v226 row_newbcast:8 row_mask:0xf bank_mask:0xf
    v_fmac_f32_dpp v99, v211, v227 row_newbcast:8 row_mask:0xf bank_mask:0xf
    v_fmac_f32_dpp v100, v212, v228 row_newbcast:8 row_mask:0xf bank_mask:0xf
    v_fmac_f32_dpp v101, v213, v229 row_newbcast:8 row_mask:0xf bank_mask:0xf
    v_fmac_f32_dpp v102, v214, v230 row_newbcast:8 row_mask:0xf bank_mask:0xf
    v_fmac_f32_dpp v103, v215, v231 row_newbcast:8 row_mask:0xf bank_mask:0xf
    v_lshlrev_b32 v224, 16, v180
    v_and_b32 v225, s90, v180
    buffer_load_dwordx4 v204, s[36:39], s71 offen offset:2048 lds
    v_lshlrev_b32 v226, 16, v181
    v_and_b32 v227, s90, v181
    v_lshlrev_b32 v228, 16, v182
    v_and_b32 v229, s90, v182
    v_lshlrev_b32 v230, 16, v183
    v_and_b32 v231, s90, v183
    v_mov_b32_dpp v104, v216 row_newbcast:9 row_mask:0xf bank_mask:0xf
    v_mov_b32_dpp v105, v217 row_newbcast:9 row_mask:0xf bank_mask:0xf
    v_mov_b32_dpp v106, v218 row_newbcast:9 row_mask:0xf bank_mask:0xf
    v_mov_b32_dpp v107, v219 row_newbcast:9 row_mask:0xf bank_mask:0xf
    v_mov_b32_dpp v108, v220 row_newbcast:9 row_mask:0xf bank_mask:0xf
    v_mov_b32_dpp v109, v221 row_newbcast:9 row_mask:0xf bank_mask:0xf
    v_mov_b32_dpp v110, v222 row_newbcast:9 row_mask:0xf bank_mask:0xf
    buffer_load_dwordx4 v205, s[36:39], s71 offen offset:3072 lds
    v_mov_b32_dpp v111, v223 row_newbcast:9 row_mask:0xf bank_mask:0xf
    v_pk_fma_f32 v[224:225], v[224:225], v[10:11], v[6:7] op_sel_hi:[1,0,0]
    v_pk_fma_f32 v[226:227], v[226:227], v[10:11], v[6:7] op_sel_hi:[1,0,0]
    v_pk_fma_f32 v[228:229], v[228:229], v[10:11], v[6:7] op_sel_hi:[1,0,0]
    v_pk_fma_f32 v[230:231], v[230:231], v[10:11], v[6:7] op_sel_hi:[1,0,0]
    v_fmac_f32_dpp v104, v208, v224 row_newbcast:9 row_mask:0xf bank_mask:0xf
    v_fmac_f32_dpp v105, v209, v225 row_newbcast:9 row_mask:0xf bank_mask:0xf
    v_fmac_f32_dpp v106, v210, v226 row_newbcast:9 row_mask:0xf bank_mask:0xf
    v_fmac_f32_dpp v107, v211, v227 row_newbcast:9 row_mask:0xf bank_mask:0xf
    v_fmac_f32_dpp v108, v212, v228 row_newbcast:9 row_mask:0xf bank_mask:0xf
    v_fmac_f32_dpp v109, v213, v229 row_newbcast:9 row_mask:0xf bank_mask:0xf
    v_fmac_f32_dpp v110, v214, v230 row_newbcast:9 row_mask:0xf bank_mask:0xf
    v_fmac_f32_dpp v111, v215, v231 row_newbcast:9 row_mask:0xf bank_mask:0xf
    s_waitcnt lgkmcnt(0)
    v_lshlrev_b32 v224, 16, v184
    v_and_b32 v225, s90, v184
    s_add_u32 m0, s70, 20480
    s_mov_b32 s71, 1490944
    buffer_load_dwordx4 v202, s[36:39], s71 offen offset:0 lds
    v_lshlrev_b32 v226, 16, v185
    v_and_b32 v227, s90, v185
    v_lshlrev_b32 v228, 16, v186
    v_and_b32 v229, s90, v186
    v_lshlrev_b32 v230, 16, v187
    v_and_b32 v231, s90, v187
    v_mov_b32_dpp v112, v216 row_newbcast:10 row_mask:0xf bank_mask:0xf
    v_mov_b32_dpp v113, v217 row_newbcast:10 row_mask:0xf bank_mask:0xf
    v_mov_b32_dpp v114, v218 row_newbcast:10 row_mask:0xf bank_mask:0xf
    v_mov_b32_dpp v115, v219 row_newbcast:10 row_mask:0xf bank_mask:0xf
    v_mov_b32_dpp v116, v220 row_newbcast:10 row_mask:0xf bank_mask:0xf
    v_mov_b32_dpp v117, v221 row_newbcast:10 row_mask:0xf bank_mask:0xf
    v_mov_b32_dpp v118, v222 row_newbcast:10 row_mask:0xf bank_mask:0xf
    buffer_load_dwordx4 v203, s[36:39], s71 offen offset:1024 lds
    v_mov_b32_dpp v119, v223 row_newbcast:10 row_mask:0xf bank_mask:0xf
    v_pk_fma_f32 v[224:225], v[224:225], v[10:11], v[6:7] op_sel_hi:[1,0,0]
    v_pk_fma_f32 v[226:227], v[226:227], v[10:11], v[6:7] op_sel_hi:[1,0,0]
    v_pk_fma_f32 v[228:229], v[228:229], v[10:11], v[6:7] op_sel_hi:[1,0,0]
    v_pk_fma_f32 v[230:231], v[230:231], v[10:11], v[6:7] op_sel_hi:[1,0,0]
    v_fmac_f32_dpp v112, v208, v224 row_newbcast:10 row_mask:0xf bank_mask:0xf
    v_fmac_f32_dpp v113, v209, v225 row_newbcast:10 row_mask:0xf bank_mask:0xf
    v_fmac_f32_dpp v114, v210, v226 row_newbcast:10 row_mask:0xf bank_mask:0xf
    v_fmac_f32_dpp v115, v211, v227 row_newbcast:10 row_mask:0xf bank_mask:0xf
    v_fmac_f32_dpp v116, v212, v228 row_newbcast:10 row_mask:0xf bank_mask:0xf
    v_fmac_f32_dpp v117, v213, v229 row_newbcast:10 row_mask:0xf bank_mask:0xf
    v_fmac_f32_dpp v118, v214, v230 row_newbcast:10 row_mask:0xf bank_mask:0xf
    v_fmac_f32_dpp v119, v215, v231 row_newbcast:10 row_mask:0xf bank_mask:0xf
    v_lshlrev_b32 v224, 16, v188
    v_and_b32 v225, s90, v188
    buffer_load_dwordx4 v204, s[36:39], s71 offen offset:2048 lds
    v_lshlrev_b32 v226, 16, v189
    v_and_b32 v227, s90, v189
    v_lshlrev_b32 v228, 16, v190
    v_and_b32 v229, s90, v190
    v_lshlrev_b32 v230, 16, v191
    v_and_b32 v231, s90, v191
    v_mov_b32_dpp v120, v216 row_newbcast:11 row_mask:0xf bank_mask:0xf
    v_mov_b32_dpp v121, v217 row_newbcast:11 row_mask:0xf bank_mask:0xf
    v_mov_b32_dpp v122, v218 row_newbcast:11 row_mask:0xf bank_mask:0xf
    v_mov_b32_dpp v123, v219 row_newbcast:11 row_mask:0xf bank_mask:0xf
    v_mov_b32_dpp v124, v220 row_newbcast:11 row_mask:0xf bank_mask:0xf
    v_mov_b32_dpp v125, v221 row_newbcast:11 row_mask:0xf bank_mask:0xf
    v_mov_b32_dpp v126, v222 row_newbcast:11 row_mask:0xf bank_mask:0xf
    buffer_load_dwordx4 v205, s[36:39], s71 offen offset:3072 lds
    v_mov_b32_dpp v127, v223 row_newbcast:11 row_mask:0xf bank_mask:0xf
    v_pk_fma_f32 v[224:225], v[224:225], v[10:11], v[6:7] op_sel_hi:[1,0,0]
    v_pk_fma_f32 v[226:227], v[226:227], v[10:11], v[6:7] op_sel_hi:[1,0,0]
    v_pk_fma_f32 v[228:229], v[228:229], v[10:11], v[6:7] op_sel_hi:[1,0,0]
    v_pk_fma_f32 v[230:231], v[230:231], v[10:11], v[6:7] op_sel_hi:[1,0,0]
    v_fmac_f32_dpp v120, v208, v224 row_newbcast:11 row_mask:0xf bank_mask:0xf
    v_fmac_f32_dpp v121, v209, v225 row_newbcast:11 row_mask:0xf bank_mask:0xf
    v_fmac_f32_dpp v122, v210, v226 row_newbcast:11 row_mask:0xf bank_mask:0xf
    v_fmac_f32_dpp v123, v211, v227 row_newbcast:11 row_mask:0xf bank_mask:0xf
    v_fmac_f32_dpp v124, v212, v228 row_newbcast:11 row_mask:0xf bank_mask:0xf
    v_fmac_f32_dpp v125, v213, v229 row_newbcast:11 row_mask:0xf bank_mask:0xf
    v_fmac_f32_dpp v126, v214, v230 row_newbcast:11 row_mask:0xf bank_mask:0xf
    v_fmac_f32_dpp v127, v215, v231 row_newbcast:11 row_mask:0xf bank_mask:0xf
    v_cmp_gt_u32 vcc, 56, v1
    v_add_u32 v232, 8, v1
    v_subrev_u32 v232, 64, v232
    v_min_u32 v232, 20, v232
    v_lshlrev_b32 v232, 6, v232
    v_add_u32 v232, 38208, v232
    v_lshlrev_b32 v233, 6, v1
    v_add_u32 v233, 40960, v233
    v_cndmask_b32 v4, v232, v233, vcc
    v_add_u32 v232, 16, v1
    v_subrev_u32 v232, 64, v232
    v_min_u32 v232, 20, v232
    v_lshlrev_b32 v232, 6, v232
    v_add_u32 v232, 38208, v232
    v_lshlrev_b32 v233, 6, v1
    v_add_u32 v233, 44544, v233
    v_cndmask_b32 v5, v232, v233, vcc
    v_add_u32 v232, 24, v1
    v_subrev_u32 v232, 64, v232
    v_min_u32 v232, 20, v232
    v_lshlrev_b32 v232, 6, v232
    v_add_u32 v232, 38208, v232
    v_lshlrev_b32 v233, 6, v1
    v_add_u32 v233, 48128, v233
    v_cndmask_b32 v7, v232, v233, vcc
    v_add_u32 v232, 32, v1
    v_subrev_u32 v232, 64, v232
    v_min_u32 v232, 20, v232
    v_lshlrev_b32 v232, 6, v232
    v_add_u32 v232, 38208, v232
    v_lshlrev_b32 v233, 6, v1
    v_add_u32 v233, 51712, v233
    v_cndmask_b32 v8, v232, v233, vcc
    s_cmp_lg_u32 s91, 0
    s_cbranch_scc1 L_w0_53
    buffer_load_dwordx2 v[240:241], v4, s[52:55], 0 offen sc1
    buffer_load_dwordx2 v[242:243], v5, s[52:55], 0 offen sc1
    buffer_load_dwordx2 v[244:245], v7, s[52:55], 0 offen sc1
    buffer_load_dwordx2 v[246:247], v8, s[52:55], 0 offen sc1
L_w0_53:
    v_lshlrev_b32 v224, 16, v192
    v_and_b32 v225, s90, v192
    v_lshlrev_b32 v226, 16, v193
    v_and_b32 v227, s90, v193
    v_lshlrev_b32 v228, 16, v194
    v_and_b32 v229, s90, v194
    v_lshlrev_b32 v230, 16, v195
    v_and_b32 v231, s90, v195
    v_mov_b32_dpp v128, v216 row_newbcast:12 row_mask:0xf bank_mask:0xf
    v_mov_b32_dpp v129, v217 row_newbcast:12 row_mask:0xf bank_mask:0xf
    v_mov_b32_dpp v130, v218 row_newbcast:12 row_mask:0xf bank_mask:0xf
    v_mov_b32_dpp v131, v219 row_newbcast:12 row_mask:0xf bank_mask:0xf
    v_mov_b32_dpp v132, v220 row_newbcast:12 row_mask:0xf bank_mask:0xf
    v_mov_b32_dpp v133, v221 row_newbcast:12 row_mask:0xf bank_mask:0xf
    v_mov_b32_dpp v134, v222 row_newbcast:12 row_mask:0xf bank_mask:0xf
    v_mov_b32_dpp v135, v223 row_newbcast:12 row_mask:0xf bank_mask:0xf
    v_pk_fma_f32 v[224:225], v[224:225], v[10:11], v[6:7] op_sel_hi:[1,0,0]
    v_pk_fma_f32 v[226:227], v[226:227], v[10:11], v[6:7] op_sel_hi:[1,0,0]
    v_pk_fma_f32 v[228:229], v[228:229], v[10:11], v[6:7] op_sel_hi:[1,0,0]
    v_pk_fma_f32 v[230:231], v[230:231], v[10:11], v[6:7] op_sel_hi:[1,0,0]
    v_fmac_f32_dpp v128, v208, v224 row_newbcast:12 row_mask:0xf bank_mask:0xf
    v_fmac_f32_dpp v129, v209, v225 row_newbcast:12 row_mask:0xf bank_mask:0xf
    v_fmac_f32_dpp v130, v210, v226 row_newbcast:12 row_mask:0xf bank_mask:0xf
    v_fmac_f32_dpp v131, v211, v227 row_newbcast:12 row_mask:0xf bank_mask:0xf
    v_fmac_f32_dpp v132, v212, v228 row_newbcast:12 row_mask:0xf bank_mask:0xf
    v_fmac_f32_dpp v133, v213, v229 row_newbcast:12 row_mask:0xf bank_mask:0xf
    v_fmac_f32_dpp v134, v214, v230 row_newbcast:12 row_mask:0xf bank_mask:0xf
    v_fmac_f32_dpp v135, v215, v231 row_newbcast:12 row_mask:0xf bank_mask:0xf
    v_lshlrev_b32 v224, 16, v196
    v_and_b32 v225, s90, v196
    v_lshlrev_b32 v226, 16, v197
    v_and_b32 v227, s90, v197
    v_lshlrev_b32 v228, 16, v198
    v_and_b32 v229, s90, v198
    v_lshlrev_b32 v230, 16, v199
    v_and_b32 v231, s90, v199
    v_mov_b32_dpp v136, v216 row_newbcast:13 row_mask:0xf bank_mask:0xf
    v_mov_b32_dpp v137, v217 row_newbcast:13 row_mask:0xf bank_mask:0xf
    v_mov_b32_dpp v138, v218 row_newbcast:13 row_mask:0xf bank_mask:0xf
    v_mov_b32_dpp v139, v219 row_newbcast:13 row_mask:0xf bank_mask:0xf
    v_mov_b32_dpp v140, v220 row_newbcast:13 row_mask:0xf bank_mask:0xf
    v_mov_b32_dpp v141, v221 row_newbcast:13 row_mask:0xf bank_mask:0xf
    v_mov_b32_dpp v142, v222 row_newbcast:13 row_mask:0xf bank_mask:0xf
    v_mov_b32_dpp v143, v223 row_newbcast:13 row_mask:0xf bank_mask:0xf
    v_pk_fma_f32 v[224:225], v[224:225], v[10:11], v[6:7] op_sel_hi:[1,0,0]
    v_pk_fma_f32 v[226:227], v[226:227], v[10:11], v[6:7] op_sel_hi:[1,0,0]
    v_pk_fma_f32 v[228:229], v[228:229], v[10:11], v[6:7] op_sel_hi:[1,0,0]
    v_pk_fma_f32 v[230:231], v[230:231], v[10:11], v[6:7] op_sel_hi:[1,0,0]
    v_fmac_f32_dpp v136, v208, v224 row_newbcast:13 row_mask:0xf bank_mask:0xf
    v_fmac_f32_dpp v137, v209, v225 row_newbcast:13 row_mask:0xf bank_mask:0xf
    v_fmac_f32_dpp v138, v210, v226 row_newbcast:13 row_mask:0xf bank_mask:0xf
    v_fmac_f32_dpp v139, v211, v227 row_newbcast:13 row_mask:0xf bank_mask:0xf
    v_fmac_f32_dpp v140, v212, v228 row_newbcast:13 row_mask:0xf bank_mask:0xf
    v_fmac_f32_dpp v141, v213, v229 row_newbcast:13 row_mask:0xf bank_mask:0xf
    v_fmac_f32_dpp v142, v214, v230 row_newbcast:13 row_mask:0xf bank_mask:0xf
    v_fmac_f32_dpp v143, v215, v231 row_newbcast:13 row_mask:0xf bank_mask:0xf
    s_getpc_b64 s[56:57]
L_cpf_54:
    s_sub_u32 s32, s56, (L_cpf_54 - adaLN_cond__ssm_conv_h3__dense_activation_silu__prompt_kernel)
    s_subb_u32 s33, s57, 0
    s_mov_b32 s34, (L_code_end - adaLN_cond__ssm_conv_h3__dense_activation_silu__prompt_kernel)
    s_mov_b32 s35, 0x20000
    s_lshl_b32 s56, s93, 2
    s_add_u32 s56, s56, s91
    s_mul_i32 s56, s56, 384
    v_and_b32 v238, 3, v1
    v_lshlrev_b32 v238, 7, v238
    v_add_u32 v238, s56, v238
    s_mov_b64 exec, 7
    buffer_load_dword v23, v238, s[32:35], 0 offen
    s_mov_b64 exec, -1
    s_add_u32 s32, s30, 2097152
    s_addc_u32 s33, s31, 0
    s_mov_b32 s34, 1835008
    s_mov_b32 s35, 0x20000
    s_mov_b32 s36, s20
    s_mov_b32 s37, s21
    s_mov_b32 s38, 1605632
    s_mov_b32 s39, 0x20000
    s_add_u32 s44, s30, 8388608
    s_addc_u32 s45, s31, 0
    s_mov_b32 s46, 7340032
    s_mov_b32 s47, 0x20000
    v_and_b32 v208, 7, v1
    v_lshlrev_b32 v209, 1, v3
    v_xor_b32 v208, v208, v209
    v_lshlrev_b32 v208, 4, v208
    v_mul_u32_u24 v202, 896, v200
    v_add_u32 v202, v202, v208
    s_lshl_b32 s57, s96, 7
    v_add_u32 v202, s57, v202
    v_add_u32 v203, 6144, v202
    v_add_u32 v204, 12288, v202
    v_add_u32 v205, 18432, v202
    v_and_b32 v10, 1, v2
    v_mul_u32_u24 v10, 896, v10
    v_lshl_add_u32 v10, v3, 4, v10
    v_add_u32 v10, 59136, v10
    s_waitcnt vmcnt(0)
    s_waitcnt lgkmcnt(0)
    s_cmp_lg_u32 s91, 0
    s_cbranch_scc1 L_w0_55
    s_mov_b32 s56, 0
    s_branch L_pfirst_58
L_poll_56:
    buffer_load_dwordx2 v[240:241], v4, s[52:55], 0 offen sc1
    buffer_load_dwordx2 v[242:243], v5, s[52:55], 0 offen sc1
    buffer_load_dwordx2 v[244:245], v7, s[52:55], 0 offen sc1
    buffer_load_dwordx2 v[246:247], v8, s[52:55], 0 offen sc1
    s_waitcnt vmcnt(0)
L_pfirst_58:
    v_cmp_ne_u64 vcc, s[88:89], v[240:241]
    v_cmp_ne_u64 s[60:61], s[88:89], v[242:243]
    s_or_b64 vcc, vcc, s[60:61]
    v_cmp_ne_u64 s[60:61], s[88:89], v[244:245]
    s_or_b64 vcc, vcc, s[60:61]
    v_cmp_ne_u64 s[60:61], s[88:89], v[246:247]
    s_or_b64 vcc, vcc, s[60:61]
    s_cmp_eq_u64 vcc, 0
    s_cbranch_scc1 L_pdone_57
    s_add_u32 s56, s56, 1
    s_cmp_lt_u32 s56, 131072
    s_cbranch_scc1 L_poll_56
L_pdone_57:
L_w0_55:
    s_barrier
    v_lshlrev_b32 v4, 4, v0
    s_movk_i32 s56, 5376
    buffer_load_dwordx4 v[224:227], v4, s[40:43], s56 offen sc1
    s_movk_i32 s56, 7168
    buffer_load_dwordx4 v[228:231], v4, s[40:43], s56 offen sc1
    s_mul_i32 s56, s91, 14
    s_lshl_b32 s57, s56, 15
    s_lshl_b32 s58, s56, 10
    s_add_u32 m0, s58, 0
    s_add_u32 s71, s57, 0
    buffer_load_dwordx4 v9, s[32:35], s71 offen offset:0 sc1 lds
    buffer_load_dwordx4 v11, s[32:35], s71 offen offset:1024 sc1 lds
    buffer_load_dwordx4 v24, s[32:35], s71 offen offset:2048 sc1 lds
    buffer_load_dwordx4 v25, s[32:35], s71 offen offset:3072 sc1 lds
    s_add_u32 m0, s58, 4096
    s_add_u32 s71, s57, 131072
    buffer_load_dwordx4 v9, s[32:35], s71 offen offset:0 sc1 lds
    buffer_load_dwordx4 v11, s[32:35], s71 offen offset:1024 sc1 lds
    buffer_load_dwordx4 v24, s[32:35], s71 offen offset:2048 sc1 lds
    buffer_load_dwordx4 v25, s[32:35], s71 offen offset:3072 sc1 lds
    s_add_u32 m0, s58, 8192
    s_add_u32 s71, s57, 262144
    buffer_load_dwordx4 v9, s[32:35], s71 offen offset:0 sc1 lds
    buffer_load_dwordx4 v11, s[32:35], s71 offen offset:1024 sc1 lds
    buffer_load_dwordx4 v24, s[32:35], s71 offen offset:2048 sc1 lds
    buffer_load_dwordx4 v25, s[32:35], s71 offen offset:3072 sc1 lds
    s_add_u32 m0, s58, 12288
    s_add_u32 s71, s57, 393216
    buffer_load_dwordx4 v9, s[32:35], s71 offen offset:0 sc1 lds
    buffer_load_dwordx4 v11, s[32:35], s71 offen offset:1024 sc1 lds
    s_mul_i32 s60, s95, 56
    s_lshl_b32 s61, s96, 3
    s_add_u32 s61, s60, s61
    s_lshl_b32 s59, s91, 1
    s_add_u32 s61, s61, s59
    s_lshl_b32 s61, s61, 12
    s_waitcnt vmcnt(14)
    v_add_f32 v228, 1.0, v228
    v_add_f32 v229, 1.0, v229
    v_add_f32 v230, 1.0, v230
    v_add_f32 v231, 1.0, v231
    v_cvt_pk_bf16_f32 v232, v228, v229
    v_cvt_pk_bf16_f32 v233, v230, v231
    v_cvt_pk_bf16_f32 v234, v224, v225
    v_cvt_pk_bf16_f32 v235, v226, v227
    v_lshlrev_b32 v228, 16, v232
    v_and_b32 v229, s90, v232
    v_lshlrev_b32 v230, 16, v233
    v_and_b32 v231, s90, v233
    v_lshrrev_b32 v5, 1, v4
    v_cmp_gt_u32 vcc, 112, v0
    s_and_saveexec_b64 s[58:59], vcc
    ds_write_b128 v4, v[228:231] offset:57344
    ds_write_b64 v5, v[232:233] offset:59136
    ds_write_b64 v5, v[234:235] offset:60032
    s_mov_b64 exec, s[58:59]
    s_waitcnt lgkmcnt(0)
    s_barrier
    ds_read_b128 v[208:211], v10 offset:0
    ds_read_b128 v[212:215], v10 offset:64
    ds_read_b128 v[216:219], v10 offset:128
    ds_read_b128 v[220:223], v10 offset:192
    s_waitcnt lgkmcnt(3)
    v_mfma_f32_16x16x32_bf16 a[224:227], a[0:3], v[208:211], 0
    ds_read_b64_tr_b16 a[128:129], v12 offset:0
    ds_read_b64_tr_b16 a[130:131], v12 offset:512
    v_mfma_f32_16x16x32_bf16 a[228:231], a[4:7], v[208:211], 0
    ds_read_b64_tr_b16 a[132:133], v13 offset:0
    ds_read_b64_tr_b16 a[134:135], v13 offset:512
    v_mfma_f32_16x16x32_bf16 a[232:235], a[8:11], v[208:211], 0
    ds_read_b64_tr_b16 a[136:137], v14 offset:0
    ds_read_b64_tr_b16 a[138:139], v14 offset:512
    v_mfma_f32_16x16x32_bf16 a[236:239], a[12:15], v[208:211], 0
    ds_read_b64_tr_b16 a[140:141], v15 offset:0
    ds_read_b64_tr_b16 a[142:143], v15 offset:512
    ds_read_b128 v[208:211], v10 offset:256
    s_waitcnt lgkmcnt(11)
    v_mfma_f32_16x16x32_bf16 a[224:227], a[16:19], v[212:215], a[224:227]
    ds_read_b64_tr_b16 a[144:145], v12 offset:4096
    ds_read_b64_tr_b16 a[146:147], v12 offset:4608
    v_mfma_f32_16x16x32_bf16 a[228:231], a[20:23], v[212:215], a[228:231]
    ds_read_b64_tr_b16 a[148:149], v13 offset:4096
    ds_read_b64_tr_b16 a[150:151], v13 offset:4608
    v_mfma_f32_16x16x32_bf16 a[232:235], a[24:27], v[212:215], a[232:235]
    ds_read_b64_tr_b16 a[152:153], v14 offset:4096
    ds_read_b64_tr_b16 a[154:155], v14 offset:4608
    v_mfma_f32_16x16x32_bf16 a[236:239], a[28:31], v[212:215], a[236:239]
    ds_read_b64_tr_b16 a[156:157], v15 offset:4096
    ds_read_b64_tr_b16 a[158:159], v15 offset:4608
    ds_read_b128 v[212:215], v10 offset:320
    s_waitcnt lgkmcnt(15)
    v_mfma_f32_16x16x32_bf16 a[224:227], a[32:35], v[216:219], a[224:227]
    ds_read_b64_tr_b16 a[160:161], v12 offset:8192
    ds_read_b64_tr_b16 a[162:163], v12 offset:8704
    v_mfma_f32_16x16x32_bf16 a[228:231], a[36:39], v[216:219], a[228:231]
    ds_read_b64_tr_b16 a[164:165], v13 offset:8192
    ds_read_b64_tr_b16 a[166:167], v13 offset:8704
    v_mfma_f32_16x16x32_bf16 a[232:235], a[40:43], v[216:219], a[232:235]
    ds_read_b64_tr_b16 a[168:169], v14 offset:8192
    ds_read_b64_tr_b16 a[170:171], v14 offset:8704
    v_mfma_f32_16x16x32_bf16 a[236:239], a[44:47], v[216:219], a[236:239]
    ds_read_b64_tr_b16 a[172:173], v15 offset:8192
    ds_read_b64_tr_b16 a[174:175], v15 offset:8704
    ds_read_b128 v[216:219], v10 offset:384
    s_waitcnt lgkmcnt(15)
    v_mfma_f32_16x16x32_bf16 a[224:227], a[48:51], v[220:223], a[224:227]
    ds_read_b64_tr_b16 a[176:177], v12 offset:12288
    ds_read_b64_tr_b16 a[178:179], v12 offset:12800
    v_mfma_f32_16x16x32_bf16 a[228:231], a[52:55], v[220:223], a[228:231]
    ds_read_b64_tr_b16 a[180:181], v13 offset:12288
    ds_read_b64_tr_b16 a[182:183], v13 offset:12800
    v_mfma_f32_16x16x32_bf16 a[232:235], a[56:59], v[220:223], a[232:235]
    ds_read_b64_tr_b16 a[184:185], v14 offset:12288
    ds_read_b64_tr_b16 a[186:187], v14 offset:12800
    v_mfma_f32_16x16x32_bf16 a[236:239], a[60:63], v[220:223], a[236:239]
    ds_read_b64_tr_b16 a[188:189], v15 offset:12288
    ds_read_b64_tr_b16 a[190:191], v15 offset:12800
    ds_read_b128 v[220:223], v10 offset:448
    s_waitcnt lgkmcnt(15)
    v_mfma_f32_16x16x32_bf16 a[224:227], a[64:67], v[208:211], a[224:227]
    ds_read_b64_tr_b16 a[192:193], v12 offset:16384
    v_mfma_f32_16x16x32_bf16 a[228:231], a[68:71], v[208:211], a[228:231]
    ds_read_b64_tr_b16 a[194:195], v12 offset:16896
    v_mfma_f32_16x16x32_bf16 a[232:235], a[72:75], v[208:211], a[232:235]
    ds_read_b64_tr_b16 a[196:197], v13 offset:16384
    v_mfma_f32_16x16x32_bf16 a[236:239], a[76:79], v[208:211], a[236:239]
    ds_read_b64_tr_b16 a[198:199], v13 offset:16896
    ds_read_b128 v[208:211], v10 offset:512
    s_waitcnt lgkmcnt(15)
    v_mfma_f32_16x16x32_bf16 a[224:227], a[80:83], v[212:215], a[224:227]
    ds_read_b64_tr_b16 a[200:201], v14 offset:16384
    v_mfma_f32_16x16x32_bf16 a[228:231], a[84:87], v[212:215], a[228:231]
    ds_read_b64_tr_b16 a[202:203], v14 offset:16896
    v_mfma_f32_16x16x32_bf16 a[232:235], a[88:91], v[212:215], a[232:235]
    ds_read_b64_tr_b16 a[204:205], v15 offset:16384
    v_mfma_f32_16x16x32_bf16 a[236:239], a[92:95], v[212:215], a[236:239]
    ds_read_b64_tr_b16 a[206:207], v15 offset:16896
    ds_read_b128 v[212:215], v10 offset:576
    s_waitcnt lgkmcnt(15)
    v_mfma_f32_16x16x32_bf16 a[224:227], a[96:99], v[216:219], a[224:227]
    ds_read_b64_tr_b16 a[208:209], v12 offset:20480
    v_mfma_f32_16x16x32_bf16 a[228:231], a[100:103], v[216:219], a[228:231]
    ds_read_b64_tr_b16 a[210:211], v12 offset:20992
    v_mfma_f32_16x16x32_bf16 a[232:235], a[104:107], v[216:219], a[232:235]
    ds_read_b64_tr_b16 a[212:213], v13 offset:20480
    v_mfma_f32_16x16x32_bf16 a[236:239], a[108:111], v[216:219], a[236:239]
    ds_read_b64_tr_b16 a[214:215], v13 offset:20992
    ds_read_b128 v[216:219], v10 offset:640
    s_waitcnt lgkmcnt(15)
    v_mfma_f32_16x16x32_bf16 a[224:227], a[112:115], v[220:223], a[224:227]
    ds_read_b64_tr_b16 a[216:217], v14 offset:20480
    v_mfma_f32_16x16x32_bf16 a[228:231], a[116:119], v[220:223], a[228:231]
    ds_read_b64_tr_b16 a[218:219], v14 offset:20992
    v_mfma_f32_16x16x32_bf16 a[232:235], a[120:123], v[220:223], a[232:235]
    ds_read_b64_tr_b16 a[220:221], v15 offset:20480
    v_mfma_f32_16x16x32_bf16 a[236:239], a[124:127], v[220:223], a[236:239]
    ds_read_b64_tr_b16 a[222:223], v15 offset:20992
    ds_read_b128 v[220:223], v10 offset:704
    s_waitcnt lgkmcnt(15)
    s_waitcnt lgkmcnt(15)
    v_mfma_f32_16x16x32_bf16 a[224:227], a[128:131], v[208:211], a[224:227]
    v_mfma_f32_16x16x32_bf16 a[228:231], a[132:135], v[208:211], a[228:231]
    v_mfma_f32_16x16x32_bf16 a[232:235], a[136:139], v[208:211], a[232:235]
    v_mfma_f32_16x16x32_bf16 a[236:239], a[140:143], v[208:211], a[236:239]
    ds_read_b128 v[208:211], v10 offset:768
    s_waitcnt lgkmcnt(11)
    s_waitcnt lgkmcnt(15)
    v_mfma_f32_16x16x32_bf16 a[224:227], a[144:147], v[212:215], a[224:227]
    v_mfma_f32_16x16x32_bf16 a[228:231], a[148:151], v[212:215], a[228:231]
    v_mfma_f32_16x16x32_bf16 a[232:235], a[152:155], v[212:215], a[232:235]
    v_mfma_f32_16x16x32_bf16 a[236:239], a[156:159], v[212:215], a[236:239]
    ds_read_b128 v[212:215], v10 offset:832
    s_waitcnt lgkmcnt(7)
    s_waitcnt lgkmcnt(15)
    v_mfma_f32_16x16x32_bf16 a[224:227], a[160:163], v[216:219], a[224:227]
    v_mfma_f32_16x16x32_bf16 a[228:231], a[164:167], v[216:219], a[228:231]
    v_mfma_f32_16x16x32_bf16 a[232:235], a[168:171], v[216:219], a[232:235]
    v_mfma_f32_16x16x32_bf16 a[236:239], a[172:175], v[216:219], a[236:239]
    s_waitcnt lgkmcnt(2)
    s_waitcnt lgkmcnt(15)
    v_mfma_f32_16x16x32_bf16 a[224:227], a[176:179], v[220:223], a[224:227]
    v_mfma_f32_16x16x32_bf16 a[228:231], a[180:183], v[220:223], a[228:231]
    v_mfma_f32_16x16x32_bf16 a[232:235], a[184:187], v[220:223], a[232:235]
    v_mfma_f32_16x16x32_bf16 a[236:239], a[188:191], v[220:223], a[236:239]
    s_waitcnt lgkmcnt(1)
    s_waitcnt lgkmcnt(13)
    v_mfma_f32_16x16x32_bf16 a[224:227], a[192:195], v[208:211], a[224:227]
    v_mfma_f32_16x16x32_bf16 a[228:231], a[196:199], v[208:211], a[228:231]
    v_mfma_f32_16x16x32_bf16 a[232:235], a[200:203], v[208:211], a[232:235]
    v_mfma_f32_16x16x32_bf16 a[236:239], a[204:207], v[208:211], a[236:239]
    s_waitcnt lgkmcnt(0)
    s_waitcnt lgkmcnt(3)
    v_mfma_f32_16x16x32_bf16 a[224:227], a[208:211], v[212:215], a[224:227]
    v_mfma_f32_16x16x32_bf16 a[228:231], a[212:215], v[212:215], a[228:231]
    v_mfma_f32_16x16x32_bf16 a[232:235], a[216:219], v[212:215], a[232:235]
    v_mfma_f32_16x16x32_bf16 a[236:239], a[220:223], v[212:215], a[236:239]
    v_lshrrev_b32 v232, 2, v2
    v_lshl_add_u32 v12, v3, 2, v232
    v_lshrrev_b32 v233, 1, v12
    v_and_b32 v233, 3, v233
    v_xor_b32 v233, 0, v233
    v_lshlrev_b32 v233, 5, v233
    v_lshlrev_b32 v12, 7, v12
    v_add_u32 v12, v12, v233
    v_and_b32 v232, 3, v2
    v_lshl_add_u32 v12, v232, 3, v12
    v_add_u32 v12, s63, v12
    v_lshrrev_b32 v232, 2, v2
    v_lshl_add_u32 v13, v3, 2, v232
    v_lshrrev_b32 v233, 1, v13
    v_and_b32 v233, 3, v233
    v_xor_b32 v233, 1, v233
    v_lshlrev_b32 v233, 5, v233
    v_lshlrev_b32 v13, 7, v13
    v_add_u32 v13, v13, v233
    v_and_b32 v232, 3, v2
    v_lshl_add_u32 v13, v232, 3, v13
    v_add_u32 v13, s63, v13
    v_lshrrev_b32 v232, 2, v2
    v_lshl_add_u32 v14, v3, 2, v232
    v_lshrrev_b32 v233, 1, v14
    v_and_b32 v233, 3, v233
    v_xor_b32 v233, 2, v233
    v_lshlrev_b32 v233, 5, v233
    v_lshlrev_b32 v14, 7, v14
    v_add_u32 v14, v14, v233
    v_and_b32 v232, 3, v2
    v_lshl_add_u32 v14, v232, 3, v14
    v_add_u32 v14, s63, v14
    v_lshrrev_b32 v232, 2, v2
    v_lshl_add_u32 v15, v3, 2, v232
    v_lshrrev_b32 v233, 1, v15
    v_and_b32 v233, 3, v233
    v_xor_b32 v233, 3, v233
    v_lshlrev_b32 v233, 5, v233
    v_lshlrev_b32 v15, 7, v15
    v_add_u32 v15, v15, v233
    v_and_b32 v232, 3, v2
    v_lshl_add_u32 v15, v232, 3, v15
    v_add_u32 v15, s63, v15
    v_lshlrev_b32 v5, 4, v1
    v_add_u32 v7, s70, v5
    s_waitcnt vmcnt(0)
    s_barrier
    v_lshlrev_b32 v21, 5, v3
    v_lshlrev_b32 v26, 7, v1
    buffer_load_dword v23, v26, s[44:47], s61 offen sc1
    ds_read_b64_tr_b16 v[208:209], v22 offset:0
    ds_read_b64_tr_b16 v[210:211], v22 offset:512
    ds_read_b64_tr_b16 v[212:213], v22 offset:4096
    ds_read_b64_tr_b16 v[214:215], v22 offset:4608
    ds_read_b64_tr_b16 v[216:217], v22 offset:8192
    ds_read_b64_tr_b16 v[218:219], v22 offset:8704
    ds_read_b128 v[240:243], v21 offset:57344
    ds_read_b128 v[244:247], v21 offset:57360
    s_waitcnt lgkmcnt(6)
    v_lshlrev_b32 v224, 16, v208
    v_and_b32 v225, s90, v208
    ds_read_b64_tr_b16 v[220:221], v22 offset:12288
    v_lshlrev_b32 v226, 16, v209
    v_and_b32 v227, s90, v209
    v_lshlrev_b32 v228, 16, v210
    v_and_b32 v229, s90, v210
    v_lshlrev_b32 v230, 16, v211
    v_and_b32 v231, s90, v211
    v_lshlrev_b32 v232, 16, v144
    v_and_b32 v233, s90, v144
    v_lshlrev_b32 v234, 16, v145
    v_and_b32 v235, s90, v145
    v_lshlrev_b32 v236, 16, v146
    ds_read_b64_tr_b16 v[222:223], v22 offset:12800
    v_and_b32 v237, s90, v146
    v_lshlrev_b32 v238, 16, v147
    v_and_b32 v239, s90, v147
    v_pk_fma_f32 v[32:33], v[32:33], v[224:225], v[232:233]
    v_pk_fma_f32 v[34:35], v[34:35], v[226:227], v[234:235]
    v_pk_fma_f32 v[36:37], v[36:37], v[228:229], v[236:237]
    v_pk_fma_f32 v[38:39], v[38:39], v[230:231], v[238:239]
    v_cvt_pk_bf16_f32 v144, v32, v33
    v_cvt_pk_bf16_f32 v145, v34, v35
    v_cvt_pk_bf16_f32 v146, v36, v37
    v_cvt_pk_bf16_f32 v147, v38, v39
    s_waitcnt lgkmcnt(2)
    v_pk_mul_f32 v[32:33], v[32:33], v[240:241]
    v_pk_mul_f32 v[34:35], v[34:35], v[242:243]
    v_pk_mul_f32 v[36:37], v[36:37], v[244:245]
    v_pk_mul_f32 v[38:39], v[38:39], v[246:247]
    ds_read_b128 v[248:251], v21 offset:57472
    v_cvt_pk_bf16_f32 v8, v32, v33
    v_cvt_pk_bf16_f32 v9, v34, v35
    ds_read_b128 v[252:255], v21 offset:57488
    v_cvt_pk_bf16_f32 v10, v36, v37
    v_cvt_pk_bf16_f32 v11, v38, v39
    s_waitcnt lgkmcnt(8)
    v_lshlrev_b32 v224, 16, v212
    v_and_b32 v225, s90, v212
    ds_write_b128 v7, v[8:11] offset:0
    v_lshlrev_b32 v226, 16, v213
    v_and_b32 v227, s90, v213
    v_lshlrev_b32 v228, 16, v214
    v_and_b32 v229, s90, v214
    v_lshlrev_b32 v230, 16, v215
    v_and_b32 v231, s90, v215
    v_mfma_f32_16x16x32_bf16 v[24:27], v[16:19], v[144:147], 0
    v_lshlrev_b32 v232, 16, v148
    ds_read_b64_tr_b16 v[208:209], v22 offset:16384
    v_and_b32 v233, s90, v148
    v_lshlrev_b32 v234, 16, v149
    v_and_b32 v235, s90, v149
    v_lshlrev_b32 v236, 16, v150
    v_and_b32 v237, s90, v150
    v_lshlrev_b32 v238, 16, v151
    v_and_b32 v239, s90, v151
    v_mfma_f32_16x16x32_bf16 v[28:31], v[144:147], v[144:147], 0
    ds_read_b64_tr_b16 v[210:211], v22 offset:16896
    v_pk_fma_f32 v[40:41], v[40:41], v[224:225], v[232:233]
    v_pk_fma_f32 v[42:43], v[42:43], v[226:227], v[234:235]
    v_pk_fma_f32 v[44:45], v[44:45], v[228:229], v[236:237]
    v_pk_fma_f32 v[46:47], v[46:47], v[230:231], v[238:239]
    v_cvt_pk_bf16_f32 v148, v40, v41
    v_cvt_pk_bf16_f32 v149, v42, v43
    v_cvt_pk_bf16_f32 v150, v44, v45
    v_cvt_pk_bf16_f32 v151, v46, v47
    s_waitcnt lgkmcnt(3)
    v_pk_mul_f32 v[40:41], v[40:41], v[248:249]
    v_pk_mul_f32 v[42:43], v[42:43], v[250:251]
    v_pk_mul_f32 v[44:45], v[44:45], v[252:253]
    v_pk_mul_f32 v[46:47], v[46:47], v[254:255]
    ds_read_b128 v[240:243], v21 offset:57600
    v_cvt_pk_bf16_f32 v8, v40, v41
    v_cvt_pk_bf16_f32 v9, v42, v43
    ds_read_b128 v[244:247], v21 offset:57616
    v_cvt_pk_bf16_f32 v10, v44, v45
    v_cvt_pk_bf16_f32 v11, v46, v47
    s_waitcnt lgkmcnt(11)
    v_lshlrev_b32 v224, 16, v216
    v_and_b32 v225, s90, v216
    ds_write_b128 v7, v[8:11] offset:1024
    v_lshlrev_b32 v226, 16, v217
    v_and_b32 v227, s90, v217
    v_lshlrev_b32 v228, 16, v218
    v_and_b32 v229, s90, v218
    v_lshlrev_b32 v230, 16, v219
    v_and_b32 v231, s90, v219
    v_mfma_f32_16x16x32_bf16 v[24:27], v[16:19], v[148:151], v[24:27]
    v_lshlrev_b32 v232, 16, v152
    ds_read_b64_tr_b16 v[212:213], v22 offset:20480
    v_and_b32 v233, s90, v152
    v_lshlrev_b32 v234, 16, v153
    v_and_b32 v235, s90, v153
    v_lshlrev_b32 v236, 16, v154
    v_and_b32 v237, s90, v154
    v_lshlrev_b32 v238, 16, v155
    v_and_b32 v239, s90, v155
    v_mfma_f32_16x16x32_bf16 v[28:31], v[148:151], v[148:151], v[28:31]
    ds_read_b64_tr_b16 v[214:215], v22 offset:20992
    v_pk_fma_f32 v[48:49], v[48:49], v[224:225], v[232:233]
    v_pk_fma_f32 v[50:51], v[50:51], v[226:227], v[234:235]
    v_pk_fma_f32 v[52:53], v[52:53], v[228:229], v[236:237]
    v_pk_fma_f32 v[54:55], v[54:55], v[230:231], v[238:239]
    v_cvt_pk_bf16_f32 v152, v48, v49
    v_cvt_pk_bf16_f32 v153, v50, v51
    v_cvt_pk_bf16_f32 v154, v52, v53
    v_cvt_pk_bf16_f32 v155, v54, v55
    s_waitcnt lgkmcnt(3)
    v_pk_mul_f32 v[48:49], v[48:49], v[240:241]
    v_pk_mul_f32 v[50:51], v[50:51], v[242:243]
    v_pk_mul_f32 v[52:53], v[52:53], v[244:245]
    v_pk_mul_f32 v[54:55], v[54:55], v[246:247]
    ds_read_b128 v[248:251], v21 offset:57728
    v_cvt_pk_bf16_f32 v8, v48, v49
    v_cvt_pk_bf16_f32 v9, v50, v51
    ds_read_b128 v[252:255], v21 offset:57744
    v_cvt_pk_bf16_f32 v10, v52, v53
    v_cvt_pk_bf16_f32 v11, v54, v55
    s_waitcnt lgkmcnt(12)
    v_lshlrev_b32 v224, 16, v220
    v_and_b32 v225, s90, v220
    ds_write_b128 v7, v[8:11] offset:2048
    v_lshlrev_b32 v226, 16, v221
    v_and_b32 v227, s90, v221
    v_lshlrev_b32 v228, 16, v222
    v_and_b32 v229, s90, v222
    v_lshlrev_b32 v230, 16, v223
    v_and_b32 v231, s90, v223
    v_mfma_f32_16x16x32_bf16 v[24:27], v[16:19], v[152:155], v[24:27]
    v_lshlrev_b32 v232, 16, v156
    ds_read_b64_tr_b16 v[216:217], v22 offset:24576
    v_and_b32 v233, s90, v156
    v_lshlrev_b32 v234, 16, v157
    v_and_b32 v235, s90, v157
    v_lshlrev_b32 v236, 16, v158
    v_and_b32 v237, s90, v158
    v_lshlrev_b32 v238, 16, v159
    v_and_b32 v239, s90, v159
    v_mfma_f32_16x16x32_bf16 v[28:31], v[152:155], v[152:155], v[28:31]
    ds_read_b64_tr_b16 v[218:219], v22 offset:25088
    v_pk_fma_f32 v[56:57], v[56:57], v[224:225], v[232:233]
    v_pk_fma_f32 v[58:59], v[58:59], v[226:227], v[234:235]
    v_pk_fma_f32 v[60:61], v[60:61], v[228:229], v[236:237]
    v_pk_fma_f32 v[62:63], v[62:63], v[230:231], v[238:239]
    v_cvt_pk_bf16_f32 v156, v56, v57
    v_cvt_pk_bf16_f32 v157, v58, v59
    v_cvt_pk_bf16_f32 v158, v60, v61
    v_cvt_pk_bf16_f32 v159, v62, v63
    s_waitcnt lgkmcnt(3)
    v_pk_mul_f32 v[56:57], v[56:57], v[248:249]
    v_pk_mul_f32 v[58:59], v[58:59], v[250:251]
    v_pk_mul_f32 v[60:61], v[60:61], v[252:253]
    v_pk_mul_f32 v[62:63], v[62:63], v[254:255]
    ds_read_b128 v[240:243], v21 offset:57856
    v_cvt_pk_bf16_f32 v8, v56, v57
    v_cvt_pk_bf16_f32 v9, v58, v59
    ds_read_b128 v[244:247], v21 offset:57872
    v_cvt_pk_bf16_f32 v10, v60, v61
    v_cvt_pk_bf16_f32 v11, v62, v63
    s_waitcnt lgkmcnt(12)
    v_lshlrev_b32 v224, 16, v208
    v_and_b32 v225, s90, v208
    ds_write_b128 v7, v[8:11] offset:3072
    v_lshlrev_b32 v226, 16, v209
    v_and_b32 v227, s90, v209
    v_lshlrev_b32 v228, 16, v210
    v_and_b32 v229, s90, v210
    v_lshlrev_b32 v230, 16, v211
    v_and_b32 v231, s90, v211
    v_mfma_f32_16x16x32_bf16 v[24:27], v[16:19], v[156:159], v[24:27]
    v_lshlrev_b32 v232, 16, v160
    ds_read_b64_tr_b16 v[220:221], v22 offset:28672
    v_and_b32 v233, s90, v160
    v_lshlrev_b32 v234, 16, v161
    v_and_b32 v235, s90, v161
    v_lshlrev_b32 v236, 16, v162
    v_and_b32 v237, s90, v162
    v_lshlrev_b32 v238, 16, v163
    v_and_b32 v239, s90, v163
    v_mfma_f32_16x16x32_bf16 v[28:31], v[156:159], v[156:159], v[28:31]
    ds_read_b64_tr_b16 v[222:223], v22 offset:29184
    v_pk_fma_f32 v[64:65], v[64:65], v[224:225], v[232:233]
    v_pk_fma_f32 v[66:67], v[66:67], v[226:227], v[234:235]
    v_pk_fma_f32 v[68:69], v[68:69], v[228:229], v[236:237]
    v_pk_fma_f32 v[70:71], v[70:71], v[230:231], v[238:239]
    v_cvt_pk_bf16_f32 v160, v64, v65
    v_cvt_pk_bf16_f32 v161, v66, v67
    v_cvt_pk_bf16_f32 v162, v68, v69
    v_cvt_pk_bf16_f32 v163, v70, v71
    s_waitcnt lgkmcnt(3)
    v_pk_mul_f32 v[64:65], v[64:65], v[240:241]
    v_pk_mul_f32 v[66:67], v[66:67], v[242:243]
    v_pk_mul_f32 v[68:69], v[68:69], v[244:245]
    v_pk_mul_f32 v[70:71], v[70:71], v[246:247]
    ds_read_b128 v[248:251], v21 offset:57984
    v_cvt_pk_bf16_f32 v8, v64, v65
    v_cvt_pk_bf16_f32 v9, v66, v67
    ds_read_b128 v[252:255], v21 offset:58000
    v_cvt_pk_bf16_f32 v10, v68, v69
    v_cvt_pk_bf16_f32 v11, v70, v71
    s_waitcnt lgkmcnt(12)
    v_lshlrev_b32 v224, 16, v212
    v_and_b32 v225, s90, v212
    ds_write_b128 v7, v[8:11] offset:4096
    v_lshlrev_b32 v226, 16, v213
    v_and_b32 v227, s90, v213
    v_lshlrev_b32 v228, 16, v214
    v_and_b32 v229, s90, v214
    v_lshlrev_b32 v230, 16, v215
    v_and_b32 v231, s90, v215
    v_mfma_f32_16x16x32_bf16 v[24:27], v[16:19], v[160:163], v[24:27]
    v_lshlrev_b32 v232, 16, v164
    ds_read_b64_tr_b16 v[208:209], v22 offset:32768
    v_and_b32 v233, s90, v164
    v_lshlrev_b32 v234, 16, v165
    v_and_b32 v235, s90, v165
    v_lshlrev_b32 v236, 16, v166
    v_and_b32 v237, s90, v166
    v_lshlrev_b32 v238, 16, v167
    v_and_b32 v239, s90, v167
    v_mfma_f32_16x16x32_bf16 v[28:31], v[160:163], v[160:163], v[28:31]
    ds_read_b64_tr_b16 v[210:211], v22 offset:33280
    v_pk_fma_f32 v[72:73], v[72:73], v[224:225], v[232:233]
    v_pk_fma_f32 v[74:75], v[74:75], v[226:227], v[234:235]
    v_pk_fma_f32 v[76:77], v[76:77], v[228:229], v[236:237]
    v_pk_fma_f32 v[78:79], v[78:79], v[230:231], v[238:239]
    v_cvt_pk_bf16_f32 v164, v72, v73
    v_cvt_pk_bf16_f32 v165, v74, v75
    v_cvt_pk_bf16_f32 v166, v76, v77
    v_cvt_pk_bf16_f32 v167, v78, v79
    s_waitcnt lgkmcnt(3)
    v_pk_mul_f32 v[72:73], v[72:73], v[248:249]
    v_pk_mul_f32 v[74:75], v[74:75], v[250:251]
    v_pk_mul_f32 v[76:77], v[76:77], v[252:253]
    v_pk_mul_f32 v[78:79], v[78:79], v[254:255]
    ds_read_b128 v[240:243], v21 offset:58112
    v_cvt_pk_bf16_f32 v8, v72, v73
    v_cvt_pk_bf16_f32 v9, v74, v75
    ds_read_b128 v[244:247], v21 offset:58128
    v_cvt_pk_bf16_f32 v10, v76, v77
    v_cvt_pk_bf16_f32 v11, v78, v79
    s_waitcnt lgkmcnt(12)
    v_lshlrev_b32 v224, 16, v216
    v_and_b32 v225, s90, v216
    ds_write_b128 v7, v[8:11] offset:5120
    v_lshlrev_b32 v226, 16, v217
    v_and_b32 v227, s90, v217
    v_lshlrev_b32 v228, 16, v218
    v_and_b32 v229, s90, v218
    v_lshlrev_b32 v230, 16, v219
    v_and_b32 v231, s90, v219
    v_mfma_f32_16x16x32_bf16 v[24:27], v[16:19], v[164:167], v[24:27]
    v_lshlrev_b32 v232, 16, v168
    ds_read_b64_tr_b16 v[212:213], v22 offset:36864
    v_and_b32 v233, s90, v168
    v_lshlrev_b32 v234, 16, v169
    v_and_b32 v235, s90, v169
    v_lshlrev_b32 v236, 16, v170
    v_and_b32 v237, s90, v170
    v_lshlrev_b32 v238, 16, v171
    v_and_b32 v239, s90, v171
    v_mfma_f32_16x16x32_bf16 v[28:31], v[164:167], v[164:167], v[28:31]
    ds_read_b64_tr_b16 v[214:215], v22 offset:37376
    v_pk_fma_f32 v[80:81], v[80:81], v[224:225], v[232:233]
    v_pk_fma_f32 v[82:83], v[82:83], v[226:227], v[234:235]
    v_pk_fma_f32 v[84:85], v[84:85], v[228:229], v[236:237]
    v_pk_fma_f32 v[86:87], v[86:87], v[230:231], v[238:239]
    v_cvt_pk_bf16_f32 v168, v80, v81
    v_cvt_pk_bf16_f32 v169, v82, v83
    v_cvt_pk_bf16_f32 v170, v84, v85
    v_cvt_pk_bf16_f32 v171, v86, v87
    s_waitcnt lgkmcnt(3)
    v_pk_mul_f32 v[80:81], v[80:81], v[240:241]
    v_pk_mul_f32 v[82:83], v[82:83], v[242:243]
    v_pk_mul_f32 v[84:85], v[84:85], v[244:245]
    v_pk_mul_f32 v[86:87], v[86:87], v[246:247]
    ds_read_b128 v[248:251], v21 offset:58240
    v_cvt_pk_bf16_f32 v8, v80, v81
    v_cvt_pk_bf16_f32 v9, v82, v83
    ds_read_b128 v[252:255], v21 offset:58256
    v_cvt_pk_bf16_f32 v10, v84, v85
    v_cvt_pk_bf16_f32 v11, v86, v87
    s_waitcnt lgkmcnt(12)
    v_lshlrev_b32 v224, 16, v220
    v_and_b32 v225, s90, v220
    ds_write_b128 v7, v[8:11] offset:6144
    v_lshlrev_b32 v226, 16, v221
    v_and_b32 v227, s90, v221
    v_lshlrev_b32 v228, 16, v222
    v_and_b32 v229, s90, v222
    v_lshlrev_b32 v230, 16, v223
    v_and_b32 v231, s90, v223
    v_mfma_f32_16x16x32_bf16 v[24:27], v[16:19], v[168:171], v[24:27]
    v_lshlrev_b32 v232, 16, v172
    ds_read_b64_tr_b16 v[216:217], v22 offset:40960
    v_and_b32 v233, s90, v172
    v_lshlrev_b32 v234, 16, v173
    v_and_b32 v235, s90, v173
    v_lshlrev_b32 v236, 16, v174
    v_and_b32 v237, s90, v174
    v_lshlrev_b32 v238, 16, v175
    v_and_b32 v239, s90, v175
    v_mfma_f32_16x16x32_bf16 v[28:31], v[168:171], v[168:171], v[28:31]
    ds_read_b64_tr_b16 v[218:219], v22 offset:41472
    v_pk_fma_f32 v[88:89], v[88:89], v[224:225], v[232:233]
    v_pk_fma_f32 v[90:91], v[90:91], v[226:227], v[234:235]
    v_pk_fma_f32 v[92:93], v[92:93], v[228:229], v[236:237]
    v_pk_fma_f32 v[94:95], v[94:95], v[230:231], v[238:239]
    v_cvt_pk_bf16_f32 v172, v88, v89
    v_cvt_pk_bf16_f32 v173, v90, v91
    v_cvt_pk_bf16_f32 v174, v92, v93
    v_cvt_pk_bf16_f32 v175, v94, v95
    s_waitcnt lgkmcnt(3)
    v_pk_mul_f32 v[88:89], v[88:89], v[248:249]
    v_pk_mul_f32 v[90:91], v[90:91], v[250:251]
    v_pk_mul_f32 v[92:93], v[92:93], v[252:253]
    v_pk_mul_f32 v[94:95], v[94:95], v[254:255]
    ds_read_b128 v[240:243], v21 offset:58368
    v_cvt_pk_bf16_f32 v8, v88, v89
    v_cvt_pk_bf16_f32 v9, v90, v91
    ds_read_b128 v[244:247], v21 offset:58384
    v_cvt_pk_bf16_f32 v10, v92, v93
    v_cvt_pk_bf16_f32 v11, v94, v95
    s_waitcnt lgkmcnt(12)
    v_lshlrev_b32 v224, 16, v208
    v_and_b32 v225, s90, v208
    ds_write_b128 v7, v[8:11] offset:7168
    v_lshlrev_b32 v226, 16, v209
    v_and_b32 v227, s90, v209
    v_lshlrev_b32 v228, 16, v210
    v_and_b32 v229, s90, v210
    v_lshlrev_b32 v230, 16, v211
    v_and_b32 v231, s90, v211
    v_mfma_f32_16x16x32_bf16 v[24:27], v[16:19], v[172:175], v[24:27]
    v_lshlrev_b32 v232, 16, v176
    ds_read_b64_tr_b16 v[220:221], v22 offset:45056
    v_and_b32 v233, s90, v176
    v_lshlrev_b32 v234, 16, v177
    v_and_b32 v235, s90, v177
    v_lshlrev_b32 v236, 16, v178
    v_and_b32 v237, s90, v178
    v_lshlrev_b32 v238, 16, v179
    v_and_b32 v239, s90, v179
    v_mfma_f32_16x16x32_bf16 v[28:31], v[172:175], v[172:175], v[28:31]
    ds_read_b64_tr_b16 v[222:223], v22 offset:45568
    v_pk_fma_f32 v[96:97], v[96:97], v[224:225], v[232:233]
    v_pk_fma_f32 v[98:99], v[98:99], v[226:227], v[234:235]
    v_pk_fma_f32 v[100:101], v[100:101], v[228:229], v[236:237]
    v_pk_fma_f32 v[102:103], v[102:103], v[230:231], v[238:239]
    v_cvt_pk_bf16_f32 v176, v96, v97
    v_cvt_pk_bf16_f32 v177, v98, v99
    v_cvt_pk_bf16_f32 v178, v100, v101
    v_cvt_pk_bf16_f32 v179, v102, v103
    s_waitcnt lgkmcnt(3)
    v_pk_mul_f32 v[96:97], v[96:97], v[240:241]
    v_pk_mul_f32 v[98:99], v[98:99], v[242:243]
    v_pk_mul_f32 v[100:101], v[100:101], v[244:245]
    v_pk_mul_f32 v[102:103], v[102:103], v[246:247]
    ds_read_b128 v[248:251], v21 offset:58496
    v_cvt_pk_bf16_f32 v8, v96, v97
    v_cvt_pk_bf16_f32 v9, v98, v99
    ds_read_b128 v[252:255], v21 offset:58512
    v_cvt_pk_bf16_f32 v10, v100, v101
    v_cvt_pk_bf16_f32 v11, v102, v103
    s_waitcnt lgkmcnt(12)
    v_lshlrev_b32 v224, 16, v212
    v_and_b32 v225, s90, v212
    ds_write_b128 v7, v[8:11] offset:8192
    v_lshlrev_b32 v226, 16, v213
    v_and_b32 v227, s90, v213
    v_lshlrev_b32 v228, 16, v214
    v_and_b32 v229, s90, v214
    v_lshlrev_b32 v230, 16, v215
    v_and_b32 v231, s90, v215
    v_mfma_f32_16x16x32_bf16 v[24:27], v[16:19], v[176:179], v[24:27]
    v_lshlrev_b32 v232, 16, v180
    ds_read_b64_tr_b16 v[208:209], v22 offset:49152
    v_and_b32 v233, s90, v180
    v_lshlrev_b32 v234, 16, v181
    v_and_b32 v235, s90, v181
    v_lshlrev_b32 v236, 16, v182
    v_and_b32 v237, s90, v182
    v_lshlrev_b32 v238, 16, v183
    v_and_b32 v239, s90, v183
    v_mfma_f32_16x16x32_bf16 v[28:31], v[176:179], v[176:179], v[28:31]
    ds_read_b64_tr_b16 v[210:211], v22 offset:49664
    v_pk_fma_f32 v[104:105], v[104:105], v[224:225], v[232:233]
    v_pk_fma_f32 v[106:107], v[106:107], v[226:227], v[234:235]
    v_pk_fma_f32 v[108:109], v[108:109], v[228:229], v[236:237]
    v_pk_fma_f32 v[110:111], v[110:111], v[230:231], v[238:239]
    v_cvt_pk_bf16_f32 v180, v104, v105
    v_cvt_pk_bf16_f32 v181, v106, v107
    v_cvt_pk_bf16_f32 v182, v108, v109
    v_cvt_pk_bf16_f32 v183, v110, v111
    s_waitcnt lgkmcnt(3)
    v_pk_mul_f32 v[104:105], v[104:105], v[248:249]
    v_pk_mul_f32 v[106:107], v[106:107], v[250:251]
    v_pk_mul_f32 v[108:109], v[108:109], v[252:253]
    v_pk_mul_f32 v[110:111], v[110:111], v[254:255]
    ds_read_b128 v[240:243], v21 offset:58624
    v_cvt_pk_bf16_f32 v8, v104, v105
    v_cvt_pk_bf16_f32 v9, v106, v107
    ds_read_b128 v[244:247], v21 offset:58640
    v_cvt_pk_bf16_f32 v10, v108, v109
    v_cvt_pk_bf16_f32 v11, v110, v111
    s_waitcnt lgkmcnt(12)
    v_lshlrev_b32 v224, 16, v216
    v_and_b32 v225, s90, v216
    ds_write_b128 v7, v[8:11] offset:9216
    v_lshlrev_b32 v226, 16, v217
    v_and_b32 v227, s90, v217
    v_lshlrev_b32 v228, 16, v218
    v_and_b32 v229, s90, v218
    v_lshlrev_b32 v230, 16, v219
    v_and_b32 v231, s90, v219
    v_mfma_f32_16x16x32_bf16 v[24:27], v[16:19], v[180:183], v[24:27]
    v_lshlrev_b32 v232, 16, v184
    ds_read_b64_tr_b16 v[212:213], v22 offset:53248
    v_and_b32 v233, s90, v184
    v_lshlrev_b32 v234, 16, v185
    v_and_b32 v235, s90, v185
    v_lshlrev_b32 v236, 16, v186
    v_and_b32 v237, s90, v186
    v_lshlrev_b32 v238, 16, v187
    v_and_b32 v239, s90, v187
    v_mfma_f32_16x16x32_bf16 v[28:31], v[180:183], v[180:183], v[28:31]
    ds_read_b64_tr_b16 v[214:215], v22 offset:53760
    v_pk_fma_f32 v[112:113], v[112:113], v[224:225], v[232:233]
    v_pk_fma_f32 v[114:115], v[114:115], v[226:227], v[234:235]
    v_pk_fma_f32 v[116:117], v[116:117], v[228:229], v[236:237]
    v_pk_fma_f32 v[118:119], v[118:119], v[230:231], v[238:239]
    v_cvt_pk_bf16_f32 v184, v112, v113
    v_cvt_pk_bf16_f32 v185, v114, v115
    v_cvt_pk_bf16_f32 v186, v116, v117
    v_cvt_pk_bf16_f32 v187, v118, v119
    s_waitcnt lgkmcnt(3)
    v_pk_mul_f32 v[112:113], v[112:113], v[240:241]
    v_pk_mul_f32 v[114:115], v[114:115], v[242:243]
    v_pk_mul_f32 v[116:117], v[116:117], v[244:245]
    v_pk_mul_f32 v[118:119], v[118:119], v[246:247]
    ds_read_b128 v[248:251], v21 offset:58752
    v_cvt_pk_bf16_f32 v8, v112, v113
    v_cvt_pk_bf16_f32 v9, v114, v115
    ds_read_b128 v[252:255], v21 offset:58768
    v_cvt_pk_bf16_f32 v10, v116, v117
    v_cvt_pk_bf16_f32 v11, v118, v119
    s_waitcnt lgkmcnt(12)
    v_lshlrev_b32 v224, 16, v220
    v_and_b32 v225, s90, v220
    ds_write_b128 v7, v[8:11] offset:10240
    v_lshlrev_b32 v226, 16, v221
    v_and_b32 v227, s90, v221
    v_lshlrev_b32 v228, 16, v222
    v_and_b32 v229, s90, v222
    v_lshlrev_b32 v230, 16, v223
    v_and_b32 v231, s90, v223
    v_mfma_f32_16x16x32_bf16 v[24:27], v[16:19], v[184:187], v[24:27]
    v_lshlrev_b32 v232, 16, v188
    v_and_b32 v233, s90, v188
    v_lshlrev_b32 v234, 16, v189
    v_and_b32 v235, s90, v189
    v_lshlrev_b32 v236, 16, v190
    v_and_b32 v237, s90, v190
    v_lshlrev_b32 v238, 16, v191
    v_and_b32 v239, s90, v191
    v_mfma_f32_16x16x32_bf16 v[28:31], v[184:187], v[184:187], v[28:31]
    v_pk_fma_f32 v[120:121], v[120:121], v[224:225], v[232:233]
    v_pk_fma_f32 v[122:123], v[122:123], v[226:227], v[234:235]
    v_pk_fma_f32 v[124:125], v[124:125], v[228:229], v[236:237]
    v_pk_fma_f32 v[126:127], v[126:127], v[230:231], v[238:239]
    v_cvt_pk_bf16_f32 v188, v120, v121
    v_cvt_pk_bf16_f32 v189, v122, v123
    v_cvt_pk_bf16_f32 v190, v124, v125
    v_cvt_pk_bf16_f32 v191, v126, v127
    s_waitcnt lgkmcnt(1)
    v_pk_mul_f32 v[120:121], v[120:121], v[248:249]
    v_pk_mul_f32 v[122:123], v[122:123], v[250:251]
    v_pk_mul_f32 v[124:125], v[124:125], v[252:253]
    v_pk_mul_f32 v[126:127], v[126:127], v[254:255]
    ds_read_b128 v[240:243], v21 offset:58880
    v_cvt_pk_bf16_f32 v8, v120, v121
    v_cvt_pk_bf16_f32 v9, v122, v123
    ds_read_b128 v[244:247], v21 offset:58896
    v_cvt_pk_bf16_f32 v10, v124, v125
    v_cvt_pk_bf16_f32 v11, v126, v127
    s_waitcnt lgkmcnt(10)
    v_lshlrev_b32 v224, 16, v208
    v_and_b32 v225, s90, v208
    ds_write_b128 v7, v[8:11] offset:11264
    v_lshlrev_b32 v226, 16, v209
    v_and_b32 v227, s90, v209
    v_lshlrev_b32 v228, 16, v210
    v_and_b32 v229, s90, v210
    v_lshlrev_b32 v230, 16, v211
    v_and_b32 v231, s90, v211
    v_mfma_f32_16x16x32_bf16 v[24:27], v[16:19], v[188:191], v[24:27]
    v_lshlrev_b32 v232, 16, v192
    v_and_b32 v233, s90, v192
    v_lshlrev_b32 v234, 16, v193
    v_and_b32 v235, s90, v193
    v_lshlrev_b32 v236, 16, v194
    v_and_b32 v237, s90, v194
    v_lshlrev_b32 v238, 16, v195
    v_and_b32 v239, s90, v195
    v_mfma_f32_16x16x32_bf16 v[28:31], v[188:191], v[188:191], v[28:31]
    v_pk_fma_f32 v[128:129], v[128:129], v[224:225], v[232:233]
    v_pk_fma_f32 v[130:131], v[130:131], v[226:227], v[234:235]
    v_pk_fma_f32 v[132:133], v[132:133], v[228:229], v[236:237]
    v_pk_fma_f32 v[134:135], v[134:135], v[230:231], v[238:239]
    v_cvt_pk_bf16_f32 v192, v128, v129
    v_cvt_pk_bf16_f32 v193, v130, v131
    v_cvt_pk_bf16_f32 v194, v132, v133
    v_cvt_pk_bf16_f32 v195, v134, v135
    s_waitcnt lgkmcnt(1)
    v_pk_mul_f32 v[128:129], v[128:129], v[240:241]
    v_pk_mul_f32 v[130:131], v[130:131], v[242:243]
    v_pk_mul_f32 v[132:133], v[132:133], v[244:245]
    v_pk_mul_f32 v[134:135], v[134:135], v[246:247]
    ds_read_b128 v[248:251], v21 offset:59008
    v_cvt_pk_bf16_f32 v8, v128, v129
    v_cvt_pk_bf16_f32 v9, v130, v131
    ds_read_b128 v[252:255], v21 offset:59024
    v_cvt_pk_bf16_f32 v10, v132, v133
    v_cvt_pk_bf16_f32 v11, v134, v135
    s_waitcnt lgkmcnt(8)
    v_lshlrev_b32 v224, 16, v212
    v_and_b32 v225, s90, v212
    ds_write_b128 v7, v[8:11] offset:12288
    v_lshlrev_b32 v226, 16, v213
    v_and_b32 v227, s90, v213
    v_lshlrev_b32 v228, 16, v214
    v_and_b32 v229, s90, v214
    v_lshlrev_b32 v230, 16, v215
    v_and_b32 v231, s90, v215
    v_mfma_f32_16x16x32_bf16 v[24:27], v[16:19], v[192:195], v[24:27]
    v_lshlrev_b32 v232, 16, v196
    v_and_b32 v233, s90, v196
    v_lshlrev_b32 v234, 16, v197
    v_and_b32 v235, s90, v197
    v_lshlrev_b32 v236, 16, v198
    v_and_b32 v237, s90, v198
    v_lshlrev_b32 v238, 16, v199
    v_and_b32 v239, s90, v199
    v_mfma_f32_16x16x32_bf16 v[28:31], v[192:195], v[192:195], v[28:31]
    v_pk_fma_f32 v[136:137], v[136:137], v[224:225], v[232:233]
    v_pk_fma_f32 v[138:139], v[138:139], v[226:227], v[234:235]
    v_pk_fma_f32 v[140:141], v[140:141], v[228:229], v[236:237]
    v_pk_fma_f32 v[142:143], v[142:143], v[230:231], v[238:239]
    v_cvt_pk_bf16_f32 v196, v136, v137
    v_cvt_pk_bf16_f32 v197, v138, v139
    v_cvt_pk_bf16_f32 v198, v140, v141
    v_cvt_pk_bf16_f32 v199, v142, v143
    s_waitcnt lgkmcnt(1)
    v_pk_mul_f32 v[136:137], v[136:137], v[248:249]
    v_pk_mul_f32 v[138:139], v[138:139], v[250:251]
    v_pk_mul_f32 v[140:141], v[140:141], v[252:253]
    v_pk_mul_f32 v[142:143], v[142:143], v[254:255]
    v_cvt_pk_bf16_f32 v8, v136, v137
    v_cvt_pk_bf16_f32 v9, v138, v139
    v_cvt_pk_bf16_f32 v10, v140, v141
    v_cvt_pk_bf16_f32 v11, v142, v143
    ds_write_b128 v7, v[8:11] offset:13312
    v_mfma_f32_16x16x32_bf16 v[24:27], v[16:19], v[196:199], v[24:27]
    s_lshl_b32 s56, s96, 3
    v_mfma_f32_16x16x32_bf16 v[28:31], v[196:199], v[196:199], v[28:31]
    s_waitcnt lgkmcnt(0)
    s_set_gpr_idx_on s56, gpr_idx(SRC0)
    v_mov_b32 v232, v144
    v_mov_b32 v233, v145
    v_mov_b32 v234, v146
    v_mov_b32 v235, v147
    v_mov_b32 v236, v148
    v_mov_b32 v237, v149
    v_mov_b32 v238, v150
    v_mov_b32 v239, v151
    s_set_gpr_idx_off
    s_barrier
    v_add_u32 v8, 60928, v5
    v_add_u32 v9, 110080, v5
    ds_read_b128 v[96:99], v8 offset:0
    ds_read_b128 v[100:103], v8 offset:24576
    ds_read_b128 v[104:107], v9 offset:0
    ds_read_b128 v[108:111], v9 offset:24576
    s_waitcnt lgkmcnt(0)
    v_mfma_f32_16x16x32_bf16 v[32:35], a[0:3], v[96:99], 0
    ds_read_b128 v[112:115], v8 offset:1024
    v_mfma_f32_16x16x32_bf16 v[36:39], a[0:3], v[100:103], 0
    ds_read_b128 v[116:119], v8 offset:25600
    v_mfma_f32_16x16x32_bf16 v[40:43], a[0:3], v[104:107], 0
    ds_read_b128 v[120:123], v9 offset:1024
    v_mfma_f32_16x16x32_bf16 v[44:47], a[0:3], v[108:111], 0
    ds_read_b128 v[124:127], v9 offset:25600
    v_mfma_f32_16x16x32_bf16 v[48:51], a[4:7], v[96:99], 0
    v_cndmask_b32 v28, v28, v29, s[64:65]
    v_mfma_f32_16x16x32_bf16 v[52:55], a[4:7], v[100:103], 0
    v_cndmask_b32 v28, v28, v30, s[66:67]
    s_add_u32 m0, s63, 0
    s_add_u32 s71, s6, 0
    s_mul_i32 s71, s71, 28672
    buffer_load_dwordx4 v202, s[36:39], s71 offen offset:0 lds
    v_mfma_f32_16x16x32_bf16 v[56:59], a[4:7], v[104:107], 0
    v_cndmask_b32 v28, v28, v31, s[68:69]
    v_mfma_f32_16x16x32_bf16 v[60:63], a[4:7], v[108:111], 0
    ds_bpermute_b32 v29, v20, v28
    v_mfma_f32_16x16x32_bf16 v[64:67], a[8:11], v[96:99], 0
    s_lshl_b32 s56, s91, 7
    s_add_u32 s56, s56, 159232
    v_mfma_f32_16x16x32_bf16 v[68:71], a[8:11], v[100:103], 0
    v_lshlrev_b32 v11, 3, v2
    buffer_load_dwordx4 v203, s[36:39], s71 offen offset:1024 lds
    v_mfma_f32_16x16x32_bf16 v[72:75], a[8:11], v[104:107], 0
    v_add_u32 v10, s56, v11
    v_mfma_f32_16x16x32_bf16 v[76:79], a[8:11], v[108:111], 0
    v_add_u32 v11, 159232, v11
    v_mfma_f32_16x16x32_bf16 v[80:83], a[12:15], v[96:99], 0
    v_mfma_f32_16x16x32_bf16 v[84:87], a[12:15], v[100:103], 0
    buffer_load_dwordx4 v204, s[36:39], s71 offen offset:2048 lds
    v_mfma_f32_16x16x32_bf16 v[88:91], a[12:15], v[104:107], 0
    v_mfma_f32_16x16x32_bf16 v[92:95], a[12:15], v[108:111], 0
    s_waitcnt lgkmcnt(0)
    v_mfma_f32_16x16x32_bf16 v[32:35], a[16:19], v[112:115], v[32:35]
    ds_read_b128 v[96:99], v8 offset:2048
    v_mfma_f32_16x16x32_bf16 v[36:39], a[16:19], v[116:119], v[36:39]
    ds_read_b128 v[100:103], v8 offset:26624
    v_mfma_f32_16x16x32_bf16 v[40:43], a[16:19], v[120:123], v[40:43]
    ds_read_b128 v[104:107], v9 offset:2048
    v_mfma_f32_16x16x32_bf16 v[44:47], a[16:19], v[124:127], v[44:47]
    ds_read_b128 v[108:111], v9 offset:26624
    v_mfma_f32_16x16x32_bf16 v[48:51], a[20:23], v[112:115], v[48:51]
    v_mul_f32 v24, 0x3b124925, v24
    v_mfma_f32_16x16x32_bf16 v[52:55], a[20:23], v[116:119], v[52:55]
    v_mul_f32 v29, 0x3b124925, v29
    buffer_load_dwordx4 v205, s[36:39], s71 offen offset:3072 lds
    v_mfma_f32_16x16x32_bf16 v[56:59], a[20:23], v[120:123], v[56:59]
    v_fma_f32 v29, -v24, v24, v29
    v_mfma_f32_16x16x32_bf16 v[60:63], a[20:23], v[124:127], v[60:63]
    v_max_f32 v29, 0, v29
    v_mfma_f32_16x16x32_bf16 v[64:67], a[24:27], v[112:115], v[64:67]
    v_add_f32 v29, 0x3727c5ac, v29
    v_mfma_f32_16x16x32_bf16 v[68:71], a[24:27], v[116:119], v[68:71]
    v_rsq_f32 v30, v29
    s_add_u32 m0, s63, 4096
    s_add_u32 s71, s6, 1
    s_mul_i32 s71, s71, 28672
    buffer_load_dwordx4 v202, s[36:39], s71 offen offset:0 lds
    v_mfma_f32_16x16x32_bf16 v[72:75], a[24:27], v[120:123], v[72:75]
    s_nop 0
    v_mfma_f32_16x16x32_bf16 v[76:79], a[24:27], v[124:127], v[76:79]
    v_mul_f32_e64 v31, -v24, v30
    v_mfma_f32_16x16x32_bf16 v[80:83], a[28:31], v[112:115], v[80:83]
    v_mul_f32 v30, 0xbfb8aa3b, v30
    v_mfma_f32_16x16x32_bf16 v[84:87], a[28:31], v[116:119], v[84:87]
    v_mov_b32 v142, 0xbfb8aa3b
    buffer_load_dwordx4 v203, s[36:39], s71 offen offset:1024 lds
    v_mfma_f32_16x16x32_bf16 v[88:91], a[28:31], v[120:123], v[88:91]
    ds_write_b64 v10, v[30:31]
    v_mfma_f32_16x16x32_bf16 v[92:95], a[28:31], v[124:127], v[92:95]
    s_waitcnt lgkmcnt(0)
    v_mfma_f32_16x16x32_bf16 v[32:35], a[32:35], v[96:99], v[32:35]
    ds_read_b128 v[112:115], v8 offset:3072
    v_mfma_f32_16x16x32_bf16 v[36:39], a[32:35], v[100:103], v[36:39]
    ds_read_b128 v[116:119], v8 offset:27648
    v_mfma_f32_16x16x32_bf16 v[40:43], a[32:35], v[104:107], v[40:43]
    ds_read_b128 v[120:123], v9 offset:3072
    v_mfma_f32_16x16x32_bf16 v[44:47], a[32:35], v[108:111], v[44:47]
    ds_read_b128 v[124:127], v9 offset:27648
    v_mfma_f32_16x16x32_bf16 v[48:51], a[36:39], v[96:99], v[48:51]
    s_sub_u32 s56, s70, s63
    v_mfma_f32_16x16x32_bf16 v[52:55], a[36:39], v[100:103], v[52:55]
    v_add_u32 v224, s56, v12
    buffer_load_dwordx4 v204, s[36:39], s71 offen offset:2048 lds
    v_mfma_f32_16x16x32_bf16 v[56:59], a[36:39], v[104:107], v[56:59]
    v_add_u32 v225, s56, v13
    v_mfma_f32_16x16x32_bf16 v[60:63], a[36:39], v[108:111], v[60:63]
    v_add_u32 v226, s56, v14
    v_mfma_f32_16x16x32_bf16 v[64:67], a[40:43], v[96:99], v[64:67]
    v_add_u32 v227, s56, v15
    v_mfma_f32_16x16x32_bf16 v[68:71], a[40:43], v[100:103], v[68:71]
    buffer_load_dwordx4 v205, s[36:39], s71 offen offset:3072 lds
    v_mfma_f32_16x16x32_bf16 v[72:75], a[40:43], v[104:107], v[72:75]
    v_mfma_f32_16x16x32_bf16 v[76:79], a[40:43], v[108:111], v[76:79]
    v_mfma_f32_16x16x32_bf16 v[80:83], a[44:47], v[96:99], v[80:83]
    v_mfma_f32_16x16x32_bf16 v[84:87], a[44:47], v[100:103], v[84:87]
    s_add_u32 m0, s63, 8192
    s_add_u32 s71, s7, 0
    s_mul_i32 s71, s71, 28672
    buffer_load_dwordx4 v202, s[36:39], s71 offen offset:0 lds
    v_mfma_f32_16x16x32_bf16 v[88:91], a[44:47], v[104:107], v[88:91]
    v_mfma_f32_16x16x32_bf16 v[92:95], a[44:47], v[108:111], v[92:95]
    s_waitcnt lgkmcnt(0)
    s_barrier
    v_mfma_f32_16x16x32_bf16 v[32:35], a[48:51], v[112:115], v[32:35]
    ds_read_b128 v[96:99], v8 offset:4096
    v_mfma_f32_16x16x32_bf16 v[36:39], a[48:51], v[116:119], v[36:39]
    ds_read_b128 v[100:103], v8 offset:28672
    v_mfma_f32_16x16x32_bf16 v[40:43], a[48:51], v[120:123], v[40:43]
    ds_read_b128 v[104:107], v9 offset:4096
    v_mfma_f32_16x16x32_bf16 v[44:47], a[48:51], v[124:127], v[44:47]
    ds_read_b128 v[108:111], v9 offset:28672
    v_mfma_f32_16x16x32_bf16 v[48:51], a[52:55], v[112:115], v[48:51]
    v_mfma_f32_16x16x32_bf16 v[52:55], a[52:55], v[116:119], v[52:55]
    buffer_load_dwordx4 v203, s[36:39], s71 offen offset:1024 lds
    v_mfma_f32_16x16x32_bf16 v[56:59], a[52:55], v[120:123], v[56:59]
    v_mfma_f32_16x16x32_bf16 v[60:63], a[52:55], v[124:127], v[60:63]
    v_mfma_f32_16x16x32_bf16 v[64:67], a[56:59], v[112:115], v[64:67]
    v_mfma_f32_16x16x32_bf16 v[68:71], a[56:59], v[116:119], v[68:71]
    buffer_load_dwordx4 v204, s[36:39], s71 offen offset:2048 lds
    v_mfma_f32_16x16x32_bf16 v[72:75], a[56:59], v[120:123], v[72:75]
    v_mfma_f32_16x16x32_bf16 v[76:79], a[56:59], v[124:127], v[76:79]
    v_mfma_f32_16x16x32_bf16 v[80:83], a[60:63], v[112:115], v[80:83]
    v_mfma_f32_16x16x32_bf16 v[84:87], a[60:63], v[116:119], v[84:87]
    buffer_load_dwordx4 v205, s[36:39], s71 offen offset:3072 lds
    v_mfma_f32_16x16x32_bf16 v[88:91], a[60:63], v[120:123], v[88:91]
    v_mfma_f32_16x16x32_bf16 v[92:95], a[60:63], v[124:127], v[92:95]
    s_waitcnt lgkmcnt(0)
    v_mfma_f32_16x16x32_bf16 v[32:35], a[64:67], v[96:99], v[32:35]
    ds_read_b128 v[112:115], v8 offset:5120
    v_mfma_f32_16x16x32_bf16 v[36:39], a[64:67], v[100:103], v[36:39]
    ds_read_b128 v[116:119], v8 offset:29696
    v_mfma_f32_16x16x32_bf16 v[40:43], a[64:67], v[104:107], v[40:43]
    ds_read_b128 v[120:123], v9 offset:5120
    v_mfma_f32_16x16x32_bf16 v[44:47], a[64:67], v[108:111], v[44:47]
    ds_read_b128 v[124:127], v9 offset:29696
    v_mfma_f32_16x16x32_bf16 v[48:51], a[68:71], v[96:99], v[48:51]
    ds_read_b64 v[128:129], v11 offset:0
    v_mfma_f32_16x16x32_bf16 v[52:55], a[68:71], v[100:103], v[52:55]
    ds_read_b64 v[130:131], v11 offset:128
    s_add_u32 m0, s70, 14336
    s_add_u32 s71, s7, 1
    s_mul_i32 s71, s71, 28672
    buffer_load_dwordx4 v202, s[36:39], s71 offen offset:0 lds
    v_mfma_f32_16x16x32_bf16 v[56:59], a[68:71], v[104:107], v[56:59]
    ds_read_b64 v[132:133], v11 offset:256
    v_mfma_f32_16x16x32_bf16 v[60:63], a[68:71], v[108:111], v[60:63]
    ds_read_b64 v[134:135], v11 offset:384
    v_mfma_f32_16x16x32_bf16 v[64:67], a[72:75], v[96:99], v[64:67]
    v_mfma_f32_16x16x32_bf16 v[68:71], a[72:75], v[100:103], v[68:71]
    buffer_load_dwordx4 v203, s[36:39], s71 offen offset:1024 lds
    v_mfma_f32_16x16x32_bf16 v[72:75], a[72:75], v[104:107], v[72:75]
    v_mfma_f32_16x16x32_bf16 v[76:79], a[72:75], v[108:111], v[76:79]
    v_mfma_f32_16x16x32_bf16 v[80:83], a[76:79], v[96:99], v[80:83]
    v_mfma_f32_16x16x32_bf16 v[84:87], a[76:79], v[100:103], v[84:87]
    buffer_load_dwordx4 v204, s[36:39], s71 offen offset:2048 lds
    v_mfma_f32_16x16x32_bf16 v[88:91], a[76:79], v[104:107], v[88:91]
    v_mfma_f32_16x16x32_bf16 v[92:95], a[76:79], v[108:111], v[92:95]
    s_waitcnt lgkmcnt(0)
    v_mfma_f32_16x16x32_bf16 v[32:35], a[80:83], v[112:115], v[32:35]
    ds_read_b128 v[96:99], v8 offset:6144
    v_mfma_f32_16x16x32_bf16 v[36:39], a[80:83], v[116:119], v[36:39]
    ds_read_b128 v[100:103], v8 offset:30720
    v_mfma_f32_16x16x32_bf16 v[40:43], a[80:83], v[120:123], v[40:43]
    ds_read_b128 v[104:107], v9 offset:6144
    v_mfma_f32_16x16x32_bf16 v[44:47], a[80:83], v[124:127], v[44:47]
    ds_read_b128 v[108:111], v9 offset:30720
    v_mfma_f32_16x16x32_bf16 v[48:51], a[84:87], v[112:115], v[48:51]
    v_accvgpr_read_b32 v136, a224
    v_mfma_f32_16x16x32_bf16 v[52:55], a[84:87], v[116:119], v[52:55]
    v_accvgpr_read_b32 v137, a225
    buffer_load_dwordx4 v205, s[36:39], s71 offen offset:3072 lds
    v_mfma_f32_16x16x32_bf16 v[56:59], a[84:87], v[120:123], v[56:59]
    v_accvgpr_read_b32 v138, a226
    v_mfma_f32_16x16x32_bf16 v[60:63], a[84:87], v[124:127], v[60:63]
    v_accvgpr_read_b32 v139, a227
    v_mfma_f32_16x16x32_bf16 v[64:67], a[88:91], v[112:115], v[64:67]
    v_mul_f32_dpp v144, v136, v142 row_newbcast:0 row_mask:0xf bank_mask:0xf
    v_mfma_f32_16x16x32_bf16 v[68:71], a[88:91], v[116:119], v[68:71]
    v_mul_f32_dpp v160, v136, v142 row_newbcast:1 row_mask:0xf bank_mask:0xf
    s_add_u32 m0, s70, 18432
    s_add_u32 s71, s8, 0
    s_mul_i32 s71, s71, 28672
    buffer_load_dwordx4 v202, s[36:39], s71 offen offset:0 lds
    v_mfma_f32_16x16x32_bf16 v[72:75], a[88:91], v[120:123], v[72:75]
    v_mul_f32_dpp v145, v137, v142 row_newbcast:0 row_mask:0xf bank_mask:0xf
    v_mfma_f32_16x16x32_bf16 v[76:79], a[88:91], v[124:127], v[76:79]
    v_mul_f32_dpp v161, v137, v142 row_newbcast:1 row_mask:0xf bank_mask:0xf
    v_mfma_f32_16x16x32_bf16 v[80:83], a[92:95], v[112:115], v[80:83]
    v_mul_f32_dpp v146, v138, v142 row_newbcast:0 row_mask:0xf bank_mask:0xf
    v_mfma_f32_16x16x32_bf16 v[84:87], a[92:95], v[116:119], v[84:87]
    v_mul_f32_dpp v162, v138, v142 row_newbcast:1 row_mask:0xf bank_mask:0xf
    buffer_load_dwordx4 v203, s[36:39], s71 offen offset:1024 lds
    v_mfma_f32_16x16x32_bf16 v[88:91], a[92:95], v[120:123], v[88:91]
    v_mul_f32_dpp v147, v139, v142 row_newbcast:0 row_mask:0xf bank_mask:0xf
    v_mfma_f32_16x16x32_bf16 v[92:95], a[92:95], v[124:127], v[92:95]
    v_mul_f32_dpp v163, v139, v142 row_newbcast:1 row_mask:0xf bank_mask:0xf
    s_waitcnt lgkmcnt(0)
    v_mfma_f32_16x16x32_bf16 v[32:35], a[96:99], v[96:99], v[32:35]
    ds_read_b128 v[112:115], v8 offset:7168
    v_mfma_f32_16x16x32_bf16 v[36:39], a[96:99], v[100:103], v[36:39]
    ds_read_b128 v[116:119], v8 offset:31744
    v_mfma_f32_16x16x32_bf16 v[40:43], a[96:99], v[104:107], v[40:43]
    ds_read_b128 v[120:123], v9 offset:7168
    v_mfma_f32_16x16x32_bf16 v[44:47], a[96:99], v[108:111], v[44:47]
    ds_read_b128 v[124:127], v9 offset:31744
    v_mfma_f32_16x16x32_bf16 v[48:51], a[100:103], v[96:99], v[48:51]
    v_accvgpr_read_b32 v136, a228
    v_mfma_f32_16x16x32_bf16 v[52:55], a[100:103], v[100:103], v[52:55]
    v_accvgpr_read_b32 v137, a229
    buffer_load_dwordx4 v204, s[36:39], s71 offen offset:2048 lds
    v_mfma_f32_16x16x32_bf16 v[56:59], a[100:103], v[104:107], v[56:59]
    v_accvgpr_read_b32 v138, a230
    v_mfma_f32_16x16x32_bf16 v[60:63], a[100:103], v[108:111], v[60:63]
    v_accvgpr_read_b32 v139, a231
    v_mfma_f32_16x16x32_bf16 v[64:67], a[104:107], v[96:99], v[64:67]
    v_mul_f32_dpp v148, v136, v142 row_newbcast:0 row_mask:0xf bank_mask:0xf
    v_mfma_f32_16x16x32_bf16 v[68:71], a[104:107], v[100:103], v[68:71]
    v_mul_f32_dpp v164, v136, v142 row_newbcast:1 row_mask:0xf bank_mask:0xf
    buffer_load_dwordx4 v205, s[36:39], s71 offen offset:3072 lds
    v_mfma_f32_16x16x32_bf16 v[72:75], a[104:107], v[104:107], v[72:75]
    v_mul_f32_dpp v149, v137, v142 row_newbcast:0 row_mask:0xf bank_mask:0xf
    v_mfma_f32_16x16x32_bf16 v[76:79], a[104:107], v[108:111], v[76:79]
    v_mul_f32_dpp v165, v137, v142 row_newbcast:1 row_mask:0xf bank_mask:0xf
    v_mfma_f32_16x16x32_bf16 v[80:83], a[108:111], v[96:99], v[80:83]
    v_mul_f32_dpp v150, v138, v142 row_newbcast:0 row_mask:0xf bank_mask:0xf
    v_mfma_f32_16x16x32_bf16 v[84:87], a[108:111], v[100:103], v[84:87]
    v_mul_f32_dpp v166, v138, v142 row_newbcast:1 row_mask:0xf bank_mask:0xf
    v_mfma_f32_16x16x32_bf16 v[88:91], a[108:111], v[104:107], v[88:91]
    v_mul_f32_dpp v151, v139, v142 row_newbcast:0 row_mask:0xf bank_mask:0xf
    v_mfma_f32_16x16x32_bf16 v[92:95], a[108:111], v[108:111], v[92:95]
    v_mul_f32_dpp v167, v139, v142 row_newbcast:1 row_mask:0xf bank_mask:0xf
    s_waitcnt lgkmcnt(0)
    v_mfma_f32_16x16x32_bf16 v[32:35], a[112:115], v[112:115], v[32:35]
    ds_read_b128 v[96:99], v8 offset:8192
    v_mfma_f32_16x16x32_bf16 v[36:39], a[112:115], v[116:119], v[36:39]
    ds_read_b128 v[100:103], v8 offset:32768
    v_mfma_f32_16x16x32_bf16 v[40:43], a[112:115], v[120:123], v[40:43]
    ds_read_b128 v[104:107], v9 offset:8192
    v_mfma_f32_16x16x32_bf16 v[44:47], a[112:115], v[124:127], v[44:47]
    ds_read_b128 v[108:111], v9 offset:32768
    v_mfma_f32_16x16x32_bf16 v[48:51], a[116:119], v[112:115], v[48:51]
    v_accvgpr_read_b32 v136, a232
    v_mfma_f32_16x16x32_bf16 v[52:55], a[116:119], v[116:119], v[52:55]
    v_accvgpr_read_b32 v137, a233
    v_mfma_f32_16x16x32_bf16 v[56:59], a[116:119], v[120:123], v[56:59]
    v_accvgpr_read_b32 v138, a234
    v_mfma_f32_16x16x32_bf16 v[60:63], a[116:119], v[124:127], v[60:63]
    v_accvgpr_read_b32 v139, a235
    v_mfma_f32_16x16x32_bf16 v[64:67], a[120:123], v[112:115], v[64:67]
    v_mul_f32_dpp v152, v136, v142 row_newbcast:0 row_mask:0xf bank_mask:0xf
    v_mfma_f32_16x16x32_bf16 v[68:71], a[120:123], v[116:119], v[68:71]
    v_mul_f32_dpp v168, v136, v142 row_newbcast:1 row_mask:0xf bank_mask:0xf
    v_mfma_f32_16x16x32_bf16 v[72:75], a[120:123], v[120:123], v[72:75]
    v_mul_f32_dpp v153, v137, v142 row_newbcast:0 row_mask:0xf bank_mask:0xf
    v_mfma_f32_16x16x32_bf16 v[76:79], a[120:123], v[124:127], v[76:79]
    v_mul_f32_dpp v169, v137, v142 row_newbcast:1 row_mask:0xf bank_mask:0xf
    v_mfma_f32_16x16x32_bf16 v[80:83], a[124:127], v[112:115], v[80:83]
    v_mul_f32_dpp v154, v138, v142 row_newbcast:0 row_mask:0xf bank_mask:0xf
    v_mfma_f32_16x16x32_bf16 v[84:87], a[124:127], v[116:119], v[84:87]
    v_mul_f32_dpp v170, v138, v142 row_newbcast:1 row_mask:0xf bank_mask:0xf
    v_mfma_f32_16x16x32_bf16 v[88:91], a[124:127], v[120:123], v[88:91]
    v_mul_f32_dpp v155, v139, v142 row_newbcast:0 row_mask:0xf bank_mask:0xf
    v_mfma_f32_16x16x32_bf16 v[92:95], a[124:127], v[124:127], v[92:95]
    v_mul_f32_dpp v171, v139, v142 row_newbcast:1 row_mask:0xf bank_mask:0xf
    s_waitcnt lgkmcnt(0)
    v_mfma_f32_16x16x32_bf16 v[32:35], a[128:131], v[96:99], v[32:35]
    ds_read_b128 v[112:115], v8 offset:9216
    v_mfma_f32_16x16x32_bf16 v[36:39], a[128:131], v[100:103], v[36:39]
    ds_read_b128 v[116:119], v8 offset:33792
    v_mfma_f32_16x16x32_bf16 v[40:43], a[128:131], v[104:107], v[40:43]
    ds_read_b128 v[120:123], v9 offset:9216
    v_mfma_f32_16x16x32_bf16 v[44:47], a[128:131], v[108:111], v[44:47]
    ds_read_b128 v[124:127], v9 offset:33792
    v_mfma_f32_16x16x32_bf16 v[48:51], a[132:135], v[96:99], v[48:51]
    v_accvgpr_read_b32 v136, a236
    v_mfma_f32_16x16x32_bf16 v[52:55], a[132:135], v[100:103], v[52:55]
    v_accvgpr_read_b32 v137, a237
    v_mfma_f32_16x16x32_bf16 v[56:59], a[132:135], v[104:107], v[56:59]
    v_accvgpr_read_b32 v138, a238
    v_mfma_f32_16x16x32_bf16 v[60:63], a[132:135], v[108:111], v[60:63]
    v_accvgpr_read_b32 v139, a239
    v_mfma_f32_16x16x32_bf16 v[64:67], a[136:139], v[96:99], v[64:67]
    v_mul_f32_dpp v156, v136, v142 row_newbcast:0 row_mask:0xf bank_mask:0xf
    v_mfma_f32_16x16x32_bf16 v[68:71], a[136:139], v[100:103], v[68:71]
    v_mul_f32_dpp v172, v136, v142 row_newbcast:1 row_mask:0xf bank_mask:0xf
    v_mfma_f32_16x16x32_bf16 v[72:75], a[136:139], v[104:107], v[72:75]
    v_mul_f32_dpp v157, v137, v142 row_newbcast:0 row_mask:0xf bank_mask:0xf
    v_mfma_f32_16x16x32_bf16 v[76:79], a[136:139], v[108:111], v[76:79]
    v_mul_f32_dpp v173, v137, v142 row_newbcast:1 row_mask:0xf bank_mask:0xf
    v_mfma_f32_16x16x32_bf16 v[80:83], a[140:143], v[96:99], v[80:83]
    v_mul_f32_dpp v158, v138, v142 row_newbcast:0 row_mask:0xf bank_mask:0xf
    v_mfma_f32_16x16x32_bf16 v[84:87], a[140:143], v[100:103], v[84:87]
    v_mul_f32_dpp v174, v138, v142 row_newbcast:1 row_mask:0xf bank_mask:0xf
    v_mfma_f32_16x16x32_bf16 v[88:91], a[140:143], v[104:107], v[88:91]
    v_mul_f32_dpp v159, v139, v142 row_newbcast:0 row_mask:0xf bank_mask:0xf
    v_mfma_f32_16x16x32_bf16 v[92:95], a[140:143], v[108:111], v[92:95]
    v_mul_f32_dpp v175, v139, v142 row_newbcast:1 row_mask:0xf bank_mask:0xf
    s_waitcnt lgkmcnt(0)
    s_waitcnt vmcnt(16)
    v_mfma_f32_16x16x32_bf16 v[32:35], a[144:147], v[112:115], v[32:35]
    ds_read_b128 v[96:99], v8 offset:10240
    v_mfma_f32_16x16x32_bf16 v[36:39], a[144:147], v[116:119], v[36:39]
    ds_read_b128 v[100:103], v8 offset:34816
    v_mfma_f32_16x16x32_bf16 v[40:43], a[144:147], v[120:123], v[40:43]
    ds_read_b128 v[104:107], v9 offset:10240
    v_mfma_f32_16x16x32_bf16 v[44:47], a[144:147], v[124:127], v[44:47]
    ds_read_b128 v[108:111], v9 offset:34816
    v_mfma_f32_16x16x32_bf16 v[48:51], a[148:151], v[112:115], v[48:51]
    ds_read_b64_tr_b16 a[0:1], v12 offset:0
    v_mfma_f32_16x16x32_bf16 v[52:55], a[148:151], v[116:119], v[52:55]
    ds_read_b64_tr_b16 a[2:3], v12 offset:2048
    v_mfma_f32_16x16x32_bf16 v[56:59], a[148:151], v[120:123], v[56:59]
    ds_read_b64_tr_b16 a[4:5], v13 offset:0
    v_mfma_f32_16x16x32_bf16 v[60:63], a[148:151], v[124:127], v[60:63]
    ds_read_b64_tr_b16 a[6:7], v13 offset:2048
    v_mfma_f32_16x16x32_bf16 v[64:67], a[152:155], v[112:115], v[64:67]
    ds_read_b64_tr_b16 a[8:9], v14 offset:0
    v_mfma_f32_16x16x32_bf16 v[68:71], a[152:155], v[116:119], v[68:71]
    ds_read_b64_tr_b16 a[10:11], v14 offset:2048
    v_mfma_f32_16x16x32_bf16 v[72:75], a[152:155], v[120:123], v[72:75]
    ds_read_b64_tr_b16 a[12:13], v15 offset:0
    v_mfma_f32_16x16x32_bf16 v[76:79], a[152:155], v[124:127], v[76:79]
    ds_read_b64_tr_b16 a[14:15], v15 offset:2048
    v_mfma_f32_16x16x32_bf16 v[80:83], a[156:159], v[112:115], v[80:83]
    v_mfma_f32_16x16x32_bf16 v[84:87], a[156:159], v[116:119], v[84:87]
    v_mfma_f32_16x16x32_bf16 v[88:91], a[156:159], v[120:123], v[88:91]
    v_mfma_f32_16x16x32_bf16 v[92:95], a[156:159], v[124:127], v[92:95]
    s_waitcnt lgkmcnt(0)
    s_waitcnt vmcnt(12)
    v_mfma_f32_16x16x32_bf16 v[32:35], a[160:163], v[96:99], v[32:35]
    ds_read_b128 v[112:115], v8 offset:11264
    v_mfma_f32_16x16x32_bf16 v[36:39], a[160:163], v[100:103], v[36:39]
    s_add_u32 m0, s63, 0
    s_add_u32 s71, s8, 1
    s_mul_i32 s71, s71, 28672
    buffer_load_dwordx4 v202, s[36:39], s71 offen offset:0 lds
    v_mfma_f32_16x16x32_bf16 v[40:43], a[160:163], v[104:107], v[40:43]
    ds_read_b128 v[116:119], v8 offset:35840
    v_mfma_f32_16x16x32_bf16 v[44:47], a[160:163], v[108:111], v[44:47]
    ds_read_b128 v[120:123], v9 offset:11264
    v_mfma_f32_16x16x32_bf16 v[48:51], a[164:167], v[96:99], v[48:51]
    ds_read_b128 v[124:127], v9 offset:35840
    v_mfma_f32_16x16x32_bf16 v[52:55], a[164:167], v[100:103], v[52:55]
    buffer_load_dwordx4 v203, s[36:39], s71 offen offset:1024 lds
    v_mfma_f32_16x16x32_bf16 v[56:59], a[164:167], v[104:107], v[56:59]
    ds_read_b64_tr_b16 a[16:17], v12 offset:4096
    v_mfma_f32_16x16x32_bf16 v[60:63], a[164:167], v[108:111], v[60:63]
    ds_read_b64_tr_b16 a[18:19], v12 offset:6144
    v_mfma_f32_16x16x32_bf16 v[64:67], a[168:171], v[96:99], v[64:67]
    ds_read_b64_tr_b16 a[20:21], v13 offset:4096
    v_mfma_f32_16x16x32_bf16 v[68:71], a[168:171], v[100:103], v[68:71]
    buffer_load_dwordx4 v204, s[36:39], s71 offen offset:2048 lds
    v_mfma_f32_16x16x32_bf16 v[72:75], a[168:171], v[104:107], v[72:75]
    ds_read_b64_tr_b16 a[22:23], v13 offset:6144
    v_mfma_f32_16x16x32_bf16 v[76:79], a[168:171], v[108:111], v[76:79]
    ds_read_b64_tr_b16 a[24:25], v14 offset:4096
    v_mfma_f32_16x16x32_bf16 v[80:83], a[172:175], v[96:99], v[80:83]
    ds_read_b64_tr_b16 a[26:27], v14 offset:6144
    v_mfma_f32_16x16x32_bf16 v[84:87], a[172:175], v[100:103], v[84:87]
    buffer_load_dwordx4 v205, s[36:39], s71 offen offset:3072 lds
    v_mfma_f32_16x16x32_bf16 v[88:91], a[172:175], v[104:107], v[88:91]
    ds_read_b64_tr_b16 a[28:29], v15 offset:4096
    v_mfma_f32_16x16x32_bf16 v[92:95], a[172:175], v[108:111], v[92:95]
    ds_read_b64_tr_b16 a[30:31], v15 offset:6144
    s_waitcnt lgkmcnt(0)
    s_waitcnt vmcnt(12)
    v_mfma_f32_16x16x32_bf16 v[32:35], a[176:179], v[112:115], v[32:35]
    ds_read_b128 v[96:99], v8 offset:12288
    v_mfma_f32_16x16x32_bf16 v[36:39], a[176:179], v[116:119], v[36:39]
    s_add_u32 m0, s63, 4096
    s_add_u32 s71, s9, 0
    s_mul_i32 s71, s71, 28672
    buffer_load_dwordx4 v202, s[36:39], s71 offen offset:0 lds
    v_mfma_f32_16x16x32_bf16 v[40:43], a[176:179], v[120:123], v[40:43]
    ds_read_b128 v[100:103], v8 offset:36864
    v_mfma_f32_16x16x32_bf16 v[44:47], a[176:179], v[124:127], v[44:47]
    ds_read_b128 v[104:107], v9 offset:12288
    v_mfma_f32_16x16x32_bf16 v[48:51], a[180:183], v[112:115], v[48:51]
    ds_read_b128 v[108:111], v9 offset:36864
    v_mfma_f32_16x16x32_bf16 v[52:55], a[180:183], v[116:119], v[52:55]
    buffer_load_dwordx4 v203, s[36:39], s71 offen offset:1024 lds
    v_mfma_f32_16x16x32_bf16 v[56:59], a[180:183], v[120:123], v[56:59]
    ds_read_b64_tr_b16 a[32:33], v12 offset:8192
    v_mfma_f32_16x16x32_bf16 v[60:63], a[180:183], v[124:127], v[60:63]
    ds_read_b64_tr_b16 a[34:35], v12 offset:10240
    v_mfma_f32_16x16x32_bf16 v[64:67], a[184:187], v[112:115], v[64:67]
    ds_read_b64_tr_b16 a[36:37], v13 offset:8192
    v_mfma_f32_16x16x32_bf16 v[68:71], a[184:187], v[116:119], v[68:71]
    buffer_load_dwordx4 v204, s[36:39], s71 offen offset:2048 lds
    v_mfma_f32_16x16x32_bf16 v[72:75], a[184:187], v[120:123], v[72:75]
    ds_read_b64_tr_b16 a[38:39], v13 offset:10240
    v_mfma_f32_16x16x32_bf16 v[76:79], a[184:187], v[124:127], v[76:79]
    ds_read_b64_tr_b16 a[40:41], v14 offset:8192
    v_mfma_f32_16x16x32_bf16 v[80:83], a[188:191], v[112:115], v[80:83]
    ds_read_b64_tr_b16 a[42:43], v14 offset:10240
    v_mfma_f32_16x16x32_bf16 v[84:87], a[188:191], v[116:119], v[84:87]
    buffer_load_dwordx4 v205, s[36:39], s71 offen offset:3072 lds
    v_mfma_f32_16x16x32_bf16 v[88:91], a[188:191], v[120:123], v[88:91]
    ds_read_b64_tr_b16 a[44:45], v15 offset:8192
    v_mfma_f32_16x16x32_bf16 v[92:95], a[188:191], v[124:127], v[92:95]
    ds_read_b64_tr_b16 a[46:47], v15 offset:10240
    s_waitcnt lgkmcnt(0)
    s_waitcnt vmcnt(12)
    v_mfma_f32_16x16x32_bf16 v[32:35], a[192:195], v[96:99], v[32:35]
    ds_read_b128 v[112:115], v8 offset:13312
    v_mfma_f32_16x16x32_bf16 v[36:39], a[192:195], v[100:103], v[36:39]
    s_add_u32 m0, s63, 8192
    s_add_u32 s71, s9, 1
    s_mul_i32 s71, s71, 28672
    buffer_load_dwordx4 v202, s[36:39], s71 offen offset:0 lds
    v_mfma_f32_16x16x32_bf16 v[40:43], a[192:195], v[104:107], v[40:43]
    ds_read_b128 v[116:119], v8 offset:37888
    v_mfma_f32_16x16x32_bf16 v[44:47], a[192:195], v[108:111], v[44:47]
    ds_read_b128 v[120:123], v9 offset:13312
    v_mfma_f32_16x16x32_bf16 v[48:51], a[196:199], v[96:99], v[48:51]
    ds_read_b128 v[124:127], v9 offset:37888
    v_mfma_f32_16x16x32_bf16 v[52:55], a[196:199], v[100:103], v[52:55]
    buffer_load_dwordx4 v203, s[36:39], s71 offen offset:1024 lds
    v_mfma_f32_16x16x32_bf16 v[56:59], a[196:199], v[104:107], v[56:59]
    ds_read_b64_tr_b16 a[48:49], v224 offset:14336
    v_mfma_f32_16x16x32_bf16 v[60:63], a[196:199], v[108:111], v[60:63]
    ds_read_b64_tr_b16 a[50:51], v224 offset:16384
    v_mfma_f32_16x16x32_bf16 v[64:67], a[200:203], v[96:99], v[64:67]
    ds_read_b64_tr_b16 a[52:53], v225 offset:14336
    v_mfma_f32_16x16x32_bf16 v[68:71], a[200:203], v[100:103], v[68:71]
    buffer_load_dwordx4 v204, s[36:39], s71 offen offset:2048 lds
    v_mfma_f32_16x16x32_bf16 v[72:75], a[200:203], v[104:107], v[72:75]
    ds_read_b64_tr_b16 a[54:55], v225 offset:16384
    v_mfma_f32_16x16x32_bf16 v[76:79], a[200:203], v[108:111], v[76:79]
    ds_read_b64_tr_b16 a[56:57], v226 offset:14336
    v_mfma_f32_16x16x32_bf16 v[80:83], a[204:207], v[96:99], v[80:83]
    ds_read_b64_tr_b16 a[58:59], v226 offset:16384
    v_mfma_f32_16x16x32_bf16 v[84:87], a[204:207], v[100:103], v[84:87]
    buffer_load_dwordx4 v205, s[36:39], s71 offen offset:3072 lds
    v_mfma_f32_16x16x32_bf16 v[88:91], a[204:207], v[104:107], v[88:91]
    ds_read_b64_tr_b16 a[60:61], v227 offset:14336
    v_mfma_f32_16x16x32_bf16 v[92:95], a[204:207], v[108:111], v[92:95]
    ds_read_b64_tr_b16 a[62:63], v227 offset:16384
    s_waitcnt lgkmcnt(0)
    s_waitcnt vmcnt(12)
    v_mfma_f32_16x16x32_bf16 v[32:35], a[208:211], v[112:115], v[32:35]
    ds_read_b64_tr_b16 a[64:65], v224 offset:18432
    v_mfma_f32_16x16x32_bf16 v[36:39], a[208:211], v[116:119], v[36:39]
    s_add_u32 m0, s70, 14336
    s_add_u32 s71, s10, 0
    s_mul_i32 s71, s71, 28672
    buffer_load_dwordx4 v202, s[36:39], s71 offen offset:0 lds
    v_mfma_f32_16x16x32_bf16 v[40:43], a[208:211], v[120:123], v[40:43]
    ds_read_b64_tr_b16 a[66:67], v224 offset:20480
    v_mfma_f32_16x16x32_bf16 v[44:47], a[208:211], v[124:127], v[44:47]
    ds_read_b64_tr_b16 a[68:69], v225 offset:18432
    v_mfma_f32_16x16x32_bf16 v[48:51], a[212:215], v[112:115], v[48:51]
    ds_read_b64_tr_b16 a[70:71], v225 offset:20480
    v_mfma_f32_16x16x32_bf16 v[52:55], a[212:215], v[116:119], v[52:55]
    buffer_load_dwordx4 v203, s[36:39], s71 offen offset:1024 lds
    v_mfma_f32_16x16x32_bf16 v[56:59], a[212:215], v[120:123], v[56:59]
    ds_read_b64_tr_b16 a[72:73], v226 offset:18432
    v_mfma_f32_16x16x32_bf16 v[60:63], a[212:215], v[124:127], v[60:63]
    ds_read_b64_tr_b16 a[74:75], v226 offset:20480
    v_mfma_f32_16x16x32_bf16 v[64:67], a[216:219], v[112:115], v[64:67]
    ds_read_b64_tr_b16 a[76:77], v227 offset:18432
    v_mfma_f32_16x16x32_bf16 v[68:71], a[216:219], v[116:119], v[68:71]
    buffer_load_dwordx4 v204, s[36:39], s71 offen offset:2048 lds
    v_mfma_f32_16x16x32_bf16 v[72:75], a[216:219], v[120:123], v[72:75]
    ds_read_b64_tr_b16 a[78:79], v227 offset:20480
    v_mfma_f32_16x16x32_bf16 v[76:79], a[216:219], v[124:127], v[76:79]
    v_mfma_f32_16x16x32_bf16 v[80:83], a[220:223], v[112:115], v[80:83]
    v_mfma_f32_16x16x32_bf16 v[84:87], a[220:223], v[116:119], v[84:87]
    buffer_load_dwordx4 v205, s[36:39], s71 offen offset:3072 lds
    v_mfma_f32_16x16x32_bf16 v[88:91], a[220:223], v[120:123], v[88:91]
    v_mfma_f32_16x16x32_bf16 v[92:95], a[220:223], v[124:127], v[92:95]
    s_waitcnt lgkmcnt(0)
    s_barrier
    s_mov_b32 s64, 0xbfb8aa3b
    s_mov_b32 s65, s64
    v_pk_fma_f32 v[180:181], v[144:145], v[128:129], v[160:161] op_sel:[0,1,0] op_sel_hi:[1,1,1]
    v_pk_fma_f32 v[182:183], v[146:147], v[128:129], v[162:163] op_sel:[0,1,0] op_sel_hi:[1,1,1]
    v_pk_fma_f32 v[184:185], v[148:149], v[128:129], v[164:165] op_sel:[0,1,0] op_sel_hi:[1,1,1]
    v_pk_fma_f32 v[186:187], v[150:151], v[128:129], v[166:167] op_sel:[0,1,0] op_sel_hi:[1,1,1]
    v_pk_fma_f32 v[32:33], v[32:33], v[128:129], v[180:181] op_sel_hi:[1,0,1]
    v_pk_fma_f32 v[34:35], v[34:35], v[128:129], v[182:183] op_sel_hi:[1,0,1]
    v_pk_fma_f32 v[48:49], v[48:49], v[128:129], v[184:185] op_sel_hi:[1,0,1]
    v_pk_fma_f32 v[50:51], v[50:51], v[128:129], v[186:187] op_sel_hi:[1,0,1]
    v_exp_f32 v180, v32
    v_exp_f32 v181, v33
    v_exp_f32 v182, v34
    v_exp_f32 v183, v35
    v_exp_f32 v184, v48
    v_exp_f32 v185, v49
    v_exp_f32 v186, v50
    v_exp_f32 v187, v51
    s_add_u32 m0, s70, 0
    s_add_u32 s71, s10, 1
    s_mul_i32 s71, s71, 28672
    buffer_load_dwordx4 v202, s[36:39], s71 offen offset:0 lds
    v_pk_fma_f32 v[180:181], v[180:181], s[64:65], s[64:65]
    v_pk_fma_f32 v[182:183], v[182:183], s[64:65], s[64:65]
    v_pk_fma_f32 v[184:185], v[184:185], s[64:65], s[64:65]
    v_pk_fma_f32 v[186:187], v[186:187], s[64:65], s[64:65]
    v_rcp_f32 v180, v180
    v_rcp_f32 v181, v181
    v_rcp_f32 v182, v182
    v_rcp_f32 v183, v183
    v_rcp_f32 v184, v184
    v_rcp_f32 v185, v185
    v_rcp_f32 v186, v186
    v_rcp_f32 v187, v187
    buffer_load_dwordx4 v203, s[36:39], s71 offen offset:1024 lds
    v_pk_mul_f32 v[180:181], v[180:181], v[32:33]
    v_pk_mul_f32 v[182:183], v[182:183], v[34:35]
    v_pk_mul_f32 v[184:185], v[184:185], v[48:49]
    v_pk_mul_f32 v[186:187], v[186:187], v[50:51]
    v_cvt_pk_bf16_f32 v96, v180, v181
    v_cvt_pk_bf16_f32 v97, v182, v183
    v_cvt_pk_bf16_f32 v98, v184, v185
    v_cvt_pk_bf16_f32 v99, v186, v187
    v_pk_fma_f32 v[180:181], v[144:145], v[130:131], v[160:161] op_sel:[0,1,0] op_sel_hi:[1,1,1]
    v_pk_fma_f32 v[182:183], v[146:147], v[130:131], v[162:163] op_sel:[0,1,0] op_sel_hi:[1,1,1]
    v_pk_fma_f32 v[184:185], v[148:149], v[130:131], v[164:165] op_sel:[0,1,0] op_sel_hi:[1,1,1]
    v_pk_fma_f32 v[186:187], v[150:151], v[130:131], v[166:167] op_sel:[0,1,0] op_sel_hi:[1,1,1]
    v_pk_fma_f32 v[36:37], v[36:37], v[130:131], v[180:181] op_sel_hi:[1,0,1]
    v_pk_fma_f32 v[38:39], v[38:39], v[130:131], v[182:183] op_sel_hi:[1,0,1]
    v_pk_fma_f32 v[52:53], v[52:53], v[130:131], v[184:185] op_sel_hi:[1,0,1]
    v_pk_fma_f32 v[54:55], v[54:55], v[130:131], v[186:187] op_sel_hi:[1,0,1]
    v_exp_f32 v180, v36
    v_exp_f32 v181, v37
    v_exp_f32 v182, v38
    v_exp_f32 v183, v39
    v_exp_f32 v184, v52
    v_exp_f32 v185, v53
    v_exp_f32 v186, v54
    v_exp_f32 v187, v55
    buffer_load_dwordx4 v204, s[36:39], s71 offen offset:2048 lds
    v_pk_fma_f32 v[180:181], v[180:181], s[64:65], s[64:65]
    v_pk_fma_f32 v[182:183], v[182:183], s[64:65], s[64:65]
    v_pk_fma_f32 v[184:185], v[184:185], s[64:65], s[64:65]
    v_pk_fma_f32 v[186:187], v[186:187], s[64:65], s[64:65]
    v_rcp_f32 v180, v180
    v_rcp_f32 v181, v181
    v_rcp_f32 v182, v182
    v_rcp_f32 v183, v183
    v_rcp_f32 v184, v184
    v_rcp_f32 v185, v185
    v_rcp_f32 v186, v186
    v_rcp_f32 v187, v187
    buffer_load_dwordx4 v205, s[36:39], s71 offen offset:3072 lds
    v_pk_mul_f32 v[180:181], v[180:181], v[36:37]
    v_pk_mul_f32 v[182:183], v[182:183], v[38:39]
    v_pk_mul_f32 v[184:185], v[184:185], v[52:53]
    v_pk_mul_f32 v[186:187], v[186:187], v[54:55]
    v_cvt_pk_bf16_f32 v100, v180, v181
    v_cvt_pk_bf16_f32 v101, v182, v183
    v_cvt_pk_bf16_f32 v102, v184, v185
    v_cvt_pk_bf16_f32 v103, v186, v187
    v_pk_fma_f32 v[180:181], v[144:145], v[132:133], v[160:161] op_sel:[0,1,0] op_sel_hi:[1,1,1]
    v_pk_fma_f32 v[182:183], v[146:147], v[132:133], v[162:163] op_sel:[0,1,0] op_sel_hi:[1,1,1]
    v_pk_fma_f32 v[184:185], v[148:149], v[132:133], v[164:165] op_sel:[0,1,0] op_sel_hi:[1,1,1]
    v_pk_fma_f32 v[186:187], v[150:151], v[132:133], v[166:167] op_sel:[0,1,0] op_sel_hi:[1,1,1]
    v_pk_fma_f32 v[40:41], v[40:41], v[132:133], v[180:181] op_sel_hi:[1,0,1]
    v_pk_fma_f32 v[42:43], v[42:43], v[132:133], v[182:183] op_sel_hi:[1,0,1]
    v_pk_fma_f32 v[56:57], v[56:57], v[132:133], v[184:185] op_sel_hi:[1,0,1]
    v_pk_fma_f32 v[58:59], v[58:59], v[132:133], v[186:187] op_sel_hi:[1,0,1]
    v_exp_f32 v180, v40
    v_exp_f32 v181, v41
    v_exp_f32 v182, v42
    v_exp_f32 v183, v43
    v_exp_f32 v184, v56
    v_exp_f32 v185, v57
    v_exp_f32 v186, v58
    v_exp_f32 v187, v59
    s_add_u32 m0, s70, 4096
    s_add_u32 s71, s11, 0
    s_mul_i32 s71, s71, 28672
    buffer_load_dwordx4 v202, s[36:39], s71 offen offset:0 lds
    v_pk_fma_f32 v[180:181], v[180:181], s[64:65], s[64:65]
    v_pk_fma_f32 v[182:183], v[182:183], s[64:65], s[64:65]
    v_pk_fma_f32 v[184:185], v[184:185], s[64:65], s[64:65]
    v_pk_fma_f32 v[186:187], v[186:187], s[64:65], s[64:65]
    v_rcp_f32 v180, v180
    v_rcp_f32 v181, v181
    v_rcp_f32 v182, v182
    v_rcp_f32 v183, v183
    v_rcp_f32 v184, v184
    v_rcp_f32 v185, v185
    v_rcp_f32 v186, v186
    v_rcp_f32 v187, v187
    buffer_load_dwordx4 v203, s[36:39], s71 offen offset:1024 lds
    v_pk_mul_f32 v[180:181], v[180:181], v[40:41]
    v_pk_mul_f32 v[182:183], v[182:183], v[42:43]
    v_pk_mul_f32 v[184:185], v[184:185], v[56:57]
    v_pk_mul_f32 v[186:187], v[186:187], v[58:59]
    v_cvt_pk_bf16_f32 v104, v180, v181
    v_cvt_pk_bf16_f32 v105, v182, v183
    v_cvt_pk_bf16_f32 v106, v184, v185
    v_cvt_pk_bf16_f32 v107, v186, v187
    v_pk_fma_f32 v[180:181], v[144:145], v[134:135], v[160:161] op_sel:[0,1,0] op_sel_hi:[1,1,1]
    v_pk_fma_f32 v[182:183], v[146:147], v[134:135], v[162:163] op_sel:[0,1,0] op_sel_hi:[1,1,1]
    v_pk_fma_f32 v[184:185], v[148:149], v[134:135], v[164:165] op_sel:[0,1,0] op_sel_hi:[1,1,1]
    v_pk_fma_f32 v[186:187], v[150:151], v[134:135], v[166:167] op_sel:[0,1,0] op_sel_hi:[1,1,1]
    v_pk_fma_f32 v[44:45], v[44:45], v[134:135], v[180:181] op_sel_hi:[1,0,1]
    v_pk_fma_f32 v[46:47], v[46:47], v[134:135], v[182:183] op_sel_hi:[1,0,1]
    v_pk_fma_f32 v[60:61], v[60:61], v[134:135], v[184:185] op_sel_hi:[1,0,1]
    v_pk_fma_f32 v[62:63], v[62:63], v[134:135], v[186:187] op_sel_hi:[1,0,1]
    v_exp_f32 v180, v44
    v_exp_f32 v181, v45
    v_exp_f32 v182, v46
    v_exp_f32 v183, v47
    v_exp_f32 v184, v60
    v_exp_f32 v185, v61
    v_exp_f32 v186, v62
    v_exp_f32 v187, v63
    buffer_load_dwordx4 v204, s[36:39], s71 offen offset:2048 lds
    v_pk_fma_f32 v[180:181], v[180:181], s[64:65], s[64:65]
    v_pk_fma_f32 v[182:183], v[182:183], s[64:65], s[64:65]
    v_pk_fma_f32 v[184:185], v[184:185], s[64:65], s[64:65]
    v_pk_fma_f32 v[186:187], v[186:187], s[64:65], s[64:65]
    v_rcp_f32 v180, v180
    v_rcp_f32 v181, v181
    v_rcp_f32 v182, v182
    v_rcp_f32 v183, v183
    v_rcp_f32 v184, v184
    v_rcp_f32 v185, v185
    v_rcp_f32 v186, v186
    v_rcp_f32 v187, v187
    buffer_load_dwordx4 v205, s[36:39], s71 offen offset:3072 lds
    v_pk_mul_f32 v[180:181], v[180:181], v[44:45]
    v_pk_mul_f32 v[182:183], v[182:183], v[46:47]
    v_pk_mul_f32 v[184:185], v[184:185], v[60:61]
    v_pk_mul_f32 v[186:187], v[186:187], v[62:63]
    v_cvt_pk_bf16_f32 v108, v180, v181
    v_cvt_pk_bf16_f32 v109, v182, v183
    v_cvt_pk_bf16_f32 v110, v184, v185
    v_cvt_pk_bf16_f32 v111, v186, v187
    v_pk_fma_f32 v[180:181], v[152:153], v[128:129], v[168:169] op_sel:[0,1,0] op_sel_hi:[1,1,1]
    v_pk_fma_f32 v[182:183], v[154:155], v[128:129], v[170:171] op_sel:[0,1,0] op_sel_hi:[1,1,1]
    v_pk_fma_f32 v[184:185], v[156:157], v[128:129], v[172:173] op_sel:[0,1,0] op_sel_hi:[1,1,1]
    v_pk_fma_f32 v[186:187], v[158:159], v[128:129], v[174:175] op_sel:[0,1,0] op_sel_hi:[1,1,1]
    v_pk_fma_f32 v[64:65], v[64:65], v[128:129], v[180:181] op_sel_hi:[1,0,1]
    v_pk_fma_f32 v[66:67], v[66:67], v[128:129], v[182:183] op_sel_hi:[1,0,1]
    v_pk_fma_f32 v[80:81], v[80:81], v[128:129], v[184:185] op_sel_hi:[1,0,1]
    v_pk_fma_f32 v[82:83], v[82:83], v[128:129], v[186:187] op_sel_hi:[1,0,1]
    v_exp_f32 v180, v64
    v_exp_f32 v181, v65
    v_exp_f32 v182, v66
    v_exp_f32 v183, v67
    v_exp_f32 v184, v80
    v_exp_f32 v185, v81
    v_exp_f32 v186, v82
    v_exp_f32 v187, v83
    s_add_u32 m0, s70, 8192
    s_add_u32 s71, s11, 1
    s_mul_i32 s71, s71, 28672
    buffer_load_dwordx4 v202, s[36:39], s71 offen offset:0 lds
    v_pk_fma_f32 v[180:181], v[180:181], s[64:65], s[64:65]
    v_pk_fma_f32 v[182:183], v[182:183], s[64:65], s[64:65]
    v_pk_fma_f32 v[184:185], v[184:185], s[64:65], s[64:65]
    v_pk_fma_f32 v[186:187], v[186:187], s[64:65], s[64:65]
    v_rcp_f32 v180, v180
    v_rcp_f32 v181, v181
    v_rcp_f32 v182, v182
    v_rcp_f32 v183, v183
    v_rcp_f32 v184, v184
    v_rcp_f32 v185, v185
    v_rcp_f32 v186, v186
    v_rcp_f32 v187, v187
    buffer_load_dwordx4 v203, s[36:39], s71 offen offset:1024 lds
    v_pk_mul_f32 v[180:181], v[180:181], v[64:65]
    v_pk_mul_f32 v[182:183], v[182:183], v[66:67]
    v_pk_mul_f32 v[184:185], v[184:185], v[80:81]
    v_pk_mul_f32 v[186:187], v[186:187], v[82:83]
    v_cvt_pk_bf16_f32 v112, v180, v181
    v_cvt_pk_bf16_f32 v113, v182, v183
    v_cvt_pk_bf16_f32 v114, v184, v185
    v_cvt_pk_bf16_f32 v115, v186, v187
    v_pk_fma_f32 v[180:181], v[152:153], v[130:131], v[168:169] op_sel:[0,1,0] op_sel_hi:[1,1,1]
    v_pk_fma_f32 v[182:183], v[154:155], v[130:131], v[170:171] op_sel:[0,1,0] op_sel_hi:[1,1,1]
    v_pk_fma_f32 v[184:185], v[156:157], v[130:131], v[172:173] op_sel:[0,1,0] op_sel_hi:[1,1,1]
    v_pk_fma_f32 v[186:187], v[158:159], v[130:131], v[174:175] op_sel:[0,1,0] op_sel_hi:[1,1,1]
    v_pk_fma_f32 v[68:69], v[68:69], v[130:131], v[180:181] op_sel_hi:[1,0,1]
    v_pk_fma_f32 v[70:71], v[70:71], v[130:131], v[182:183] op_sel_hi:[1,0,1]
    v_pk_fma_f32 v[84:85], v[84:85], v[130:131], v[184:185] op_sel_hi:[1,0,1]
    v_pk_fma_f32 v[86:87], v[86:87], v[130:131], v[186:187] op_sel_hi:[1,0,1]
    v_exp_f32 v180, v68
    v_exp_f32 v181, v69
    v_exp_f32 v182, v70
    v_exp_f32 v183, v71
    v_exp_f32 v184, v84
    v_exp_f32 v185, v85
    v_exp_f32 v186, v86
    v_exp_f32 v187, v87
    buffer_load_dwordx4 v204, s[36:39], s71 offen offset:2048 lds
    v_pk_fma_f32 v[180:181], v[180:181], s[64:65], s[64:65]
    v_pk_fma_f32 v[182:183], v[182:183], s[64:65], s[64:65]
    v_pk_fma_f32 v[184:185], v[184:185], s[64:65], s[64:65]
    v_pk_fma_f32 v[186:187], v[186:187], s[64:65], s[64:65]
    v_rcp_f32 v180, v180
    v_rcp_f32 v181, v181
    v_rcp_f32 v182, v182
    v_rcp_f32 v183, v183
    v_rcp_f32 v184, v184
    v_rcp_f32 v185, v185
    v_rcp_f32 v186, v186
    v_rcp_f32 v187, v187
    buffer_load_dwordx4 v205, s[36:39], s71 offen offset:3072 lds
    v_pk_mul_f32 v[180:181], v[180:181], v[68:69]
    v_pk_mul_f32 v[182:183], v[182:183], v[70:71]
    v_pk_mul_f32 v[184:185], v[184:185], v[84:85]
    v_pk_mul_f32 v[186:187], v[186:187], v[86:87]
    v_cvt_pk_bf16_f32 v116, v180, v181
    v_cvt_pk_bf16_f32 v117, v182, v183
    v_cvt_pk_bf16_f32 v118, v184, v185
    v_cvt_pk_bf16_f32 v119, v186, v187
    v_pk_fma_f32 v[180:181], v[152:153], v[132:133], v[168:169] op_sel:[0,1,0] op_sel_hi:[1,1,1]
    v_pk_fma_f32 v[182:183], v[154:155], v[132:133], v[170:171] op_sel:[0,1,0] op_sel_hi:[1,1,1]
    v_pk_fma_f32 v[184:185], v[156:157], v[132:133], v[172:173] op_sel:[0,1,0] op_sel_hi:[1,1,1]
    v_pk_fma_f32 v[186:187], v[158:159], v[132:133], v[174:175] op_sel:[0,1,0] op_sel_hi:[1,1,1]
    v_pk_fma_f32 v[72:73], v[72:73], v[132:133], v[180:181] op_sel_hi:[1,0,1]
    v_pk_fma_f32 v[74:75], v[74:75], v[132:133], v[182:183] op_sel_hi:[1,0,1]
    v_pk_fma_f32 v[88:89], v[88:89], v[132:133], v[184:185] op_sel_hi:[1,0,1]
    v_pk_fma_f32 v[90:91], v[90:91], v[132:133], v[186:187] op_sel_hi:[1,0,1]
    v_exp_f32 v180, v72
    v_exp_f32 v181, v73
    v_exp_f32 v182, v74
    v_exp_f32 v183, v75
    v_exp_f32 v184, v88
    v_exp_f32 v185, v89
    v_exp_f32 v186, v90
    v_exp_f32 v187, v91
    s_add_u32 m0, s70, 18432
    s_add_u32 s71, s12, 0
    s_mul_i32 s71, s71, 28672
    buffer_load_dwordx4 v202, s[36:39], s71 offen offset:0 lds
    v_pk_fma_f32 v[180:181], v[180:181], s[64:65], s[64:65]
    v_pk_fma_f32 v[182:183], v[182:183], s[64:65], s[64:65]
    v_pk_fma_f32 v[184:185], v[184:185], s[64:65], s[64:65]
    v_pk_fma_f32 v[186:187], v[186:187], s[64:65], s[64:65]
    v_rcp_f32 v180, v180
    v_rcp_f32 v181, v181
    v_rcp_f32 v182, v182
    v_rcp_f32 v183, v183
    v_rcp_f32 v184, v184
    v_rcp_f32 v185, v185
    v_rcp_f32 v186, v186
    v_rcp_f32 v187, v187
    buffer_load_dwordx4 v203, s[36:39], s71 offen offset:1024 lds
    v_pk_mul_f32 v[180:181], v[180:181], v[72:73]
    v_pk_mul_f32 v[182:183], v[182:183], v[74:75]
    v_pk_mul_f32 v[184:185], v[184:185], v[88:89]
    v_pk_mul_f32 v[186:187], v[186:187], v[90:91]
    v_cvt_pk_bf16_f32 v120, v180, v181
    v_cvt_pk_bf16_f32 v121, v182, v183
    v_cvt_pk_bf16_f32 v122, v184, v185
    v_cvt_pk_bf16_f32 v123, v186, v187
    v_pk_fma_f32 v[180:181], v[152:153], v[134:135], v[168:169] op_sel:[0,1,0] op_sel_hi:[1,1,1]
    v_pk_fma_f32 v[182:183], v[154:155], v[134:135], v[170:171] op_sel:[0,1,0] op_sel_hi:[1,1,1]
    v_pk_fma_f32 v[184:185], v[156:157], v[134:135], v[172:173] op_sel:[0,1,0] op_sel_hi:[1,1,1]
    v_pk_fma_f32 v[186:187], v[158:159], v[134:135], v[174:175] op_sel:[0,1,0] op_sel_hi:[1,1,1]
    v_pk_fma_f32 v[76:77], v[76:77], v[134:135], v[180:181] op_sel_hi:[1,0,1]
    v_pk_fma_f32 v[78:79], v[78:79], v[134:135], v[182:183] op_sel_hi:[1,0,1]
    v_pk_fma_f32 v[92:93], v[92:93], v[134:135], v[184:185] op_sel_hi:[1,0,1]
    v_pk_fma_f32 v[94:95], v[94:95], v[134:135], v[186:187] op_sel_hi:[1,0,1]
    v_exp_f32 v180, v76
    v_exp_f32 v181, v77
    v_exp_f32 v182, v78
    v_exp_f32 v183, v79
    v_exp_f32 v184, v92
    v_exp_f32 v185, v93
    v_exp_f32 v186, v94
    v_exp_f32 v187, v95
    buffer_load_dwordx4 v204, s[36:39], s71 offen offset:2048 lds
    v_pk_fma_f32 v[180:181], v[180:181], s[64:65], s[64:65]
    v_pk_fma_f32 v[182:183], v[182:183], s[64:65], s[64:65]
    v_pk_fma_f32 v[184:185], v[184:185], s[64:65], s[64:65]
    v_pk_fma_f32 v[186:187], v[186:187], s[64:65], s[64:65]
    v_rcp_f32 v180, v180
    v_rcp_f32 v181, v181
    v_rcp_f32 v182, v182
    v_rcp_f32 v183, v183
    v_rcp_f32 v184, v184
    v_rcp_f32 v185, v185
    v_rcp_f32 v186, v186
    v_rcp_f32 v187, v187
    buffer_load_dwordx4 v205, s[36:39], s71 offen offset:3072 lds
    v_pk_mul_f32 v[180:181], v[180:181], v[76:77]
    v_pk_mul_f32 v[182:183], v[182:183], v[78:79]
    v_pk_mul_f32 v[184:185], v[184:185], v[92:93]
    v_pk_mul_f32 v[186:187], v[186:187], v[94:95]
    v_cvt_pk_bf16_f32 v124, v180, v181
    v_cvt_pk_bf16_f32 v125, v182, v183
    v_cvt_pk_bf16_f32 v126, v184, v185
    v_cvt_pk_bf16_f32 v127, v186, v187
    s_cmp_eq_u32 s94, 0
    s_cbranch_scc1 L_hg_59
    s_add_u32 s59, s61, 4096
    buffer_store_dwordx4 v[96:99], v5, s[44:47], s61 offen offset:0 nt
    buffer_store_dwordx4 v[100:103], v5, s[44:47], s61 offen offset:1024 nt
    buffer_store_dwordx4 v[104:107], v5, s[44:47], s61 offen offset:2048 nt
    buffer_store_dwordx4 v[108:111], v5, s[44:47], s61 offen offset:3072 nt
    buffer_store_dwordx4 v[112:115], v5, s[44:47], s59 offen offset:0 nt
    buffer_store_dwordx4 v[116:119], v5, s[44:47], s59 offen offset:1024 nt
    buffer_store_dwordx4 v[120:123], v5, s[44:47], s59 offen offset:2048 nt
    buffer_store_dwordx4 v[124:127], v5, s[44:47], s59 offen offset:3072 nt
    s_branch L_hd_60
L_hg_59:
    s_add_u32 s59, s61, 4096
    buffer_store_dwordx4 v[96:99], v5, s[44:47], s61 offen offset:0 sc1
    buffer_store_dwordx4 v[100:103], v5, s[44:47], s61 offen offset:1024 sc1
    buffer_store_dwordx4 v[104:107], v5, s[44:47], s61 offen offset:2048 sc1
    buffer_store_dwordx4 v[108:111], v5, s[44:47], s61 offen offset:3072 sc1
    buffer_store_dwordx4 v[112:115], v5, s[44:47], s59 offen offset:0 sc1
    buffer_store_dwordx4 v[116:119], v5, s[44:47], s59 offen offset:1024 sc1
    buffer_store_dwordx4 v[120:123], v5, s[44:47], s59 offen offset:2048 sc1
    buffer_store_dwordx4 v[124:127], v5, s[44:47], s59 offen offset:3072 sc1
L_hd_60:
    v_mfma_f32_16x16x32_bf16 v[32:35], a[0:3], v[96:99], 0
    v_mfma_f32_16x16x32_bf16 v[36:39], a[0:3], v[100:103], 0
    v_mfma_f32_16x16x32_bf16 v[40:43], a[0:3], v[104:107], 0
    v_mfma_f32_16x16x32_bf16 v[44:47], a[0:3], v[108:111], 0
    v_mfma_f32_16x16x32_bf16 v[48:51], a[4:7], v[96:99], 0
    v_mfma_f32_16x16x32_bf16 v[52:55], a[4:7], v[100:103], 0
    v_mfma_f32_16x16x32_bf16 v[56:59], a[4:7], v[104:107], 0
    v_mfma_f32_16x16x32_bf16 v[60:63], a[4:7], v[108:111], 0
    v_mfma_f32_16x16x32_bf16 v[64:67], a[8:11], v[96:99], 0
    v_mfma_f32_16x16x32_bf16 v[68:71], a[8:11], v[100:103], 0
    v_mfma_f32_16x16x32_bf16 v[72:75], a[8:11], v[104:107], 0
    v_mfma_f32_16x16x32_bf16 v[76:79], a[8:11], v[108:111], 0
    v_mfma_f32_16x16x32_bf16 v[80:83], a[12:15], v[96:99], 0
    v_mfma_f32_16x16x32_bf16 v[84:87], a[12:15], v[100:103], 0
    v_mfma_f32_16x16x32_bf16 v[88:91], a[12:15], v[104:107], 0
    v_mfma_f32_16x16x32_bf16 v[92:95], a[12:15], v[108:111], 0
    v_mfma_f32_16x16x32_bf16 v[32:35], a[16:19], v[112:115], v[32:35]
    v_mfma_f32_16x16x32_bf16 v[36:39], a[16:19], v[116:119], v[36:39]
    v_mfma_f32_16x16x32_bf16 v[40:43], a[16:19], v[120:123], v[40:43]
    v_mfma_f32_16x16x32_bf16 v[44:47], a[16:19], v[124:127], v[44:47]
    v_mfma_f32_16x16x32_bf16 v[48:51], a[20:23], v[112:115], v[48:51]
    v_mfma_f32_16x16x32_bf16 v[52:55], a[20:23], v[116:119], v[52:55]
    v_mfma_f32_16x16x32_bf16 v[56:59], a[20:23], v[120:123], v[56:59]
    v_mfma_f32_16x16x32_bf16 v[60:63], a[20:23], v[124:127], v[60:63]
    v_mfma_f32_16x16x32_bf16 v[64:67], a[24:27], v[112:115], v[64:67]
    v_mfma_f32_16x16x32_bf16 v[68:71], a[24:27], v[116:119], v[68:71]
    v_mfma_f32_16x16x32_bf16 v[72:75], a[24:27], v[120:123], v[72:75]
    v_mfma_f32_16x16x32_bf16 v[76:79], a[24:27], v[124:127], v[76:79]
    v_mfma_f32_16x16x32_bf16 v[80:83], a[28:31], v[112:115], v[80:83]
    v_mfma_f32_16x16x32_bf16 v[84:87], a[28:31], v[116:119], v[84:87]
    v_mfma_f32_16x16x32_bf16 v[88:91], a[28:31], v[120:123], v[88:91]
    v_mfma_f32_16x16x32_bf16 v[92:95], a[28:31], v[124:127], v[92:95]
    s_waitcnt vmcnt(0)
    s_barrier
    s_mul_i32 s57, s95, 7
    s_add_u32 s57, s57, s96
    s_lshl_b32 s57, s57, 6
    s_cmp_lg_u32 s91, 0
    s_cbranch_scc1 L_w0_61
    s_add_u32 s56, s57, 57344
    v_mov_b32 v250, s56
    v_mov_b32 v252, s88
    v_mov_b32 v253, s89
    s_mov_b64 exec, 1
    s_cmp_eq_u32 s94, 0
    s_cbranch_scc1 L_sg_62
    buffer_store_dwordx2 v[252:253], v250, s[52:55], 0 offen
    s_branch L_sd_63
L_sg_62:
    buffer_store_dwordx2 v[252:253], v250, s[52:55], 0 offen sc1
L_sd_63:
    s_mov_b64 exec, -1
L_w0_61:
    s_add_u32 s40, s30, 4194304
    s_addc_u32 s41, s31, 0
    s_mov_b32 s42, 10752
    s_mov_b32 s43, 0x20000
    s_mov_b32 s32, s26
    s_mov_b32 s33, s27
    s_mov_b32 s34, 1835008
    s_mov_b32 s35, 0x20000
    s_lshl_b32 s56, s96, 8
    s_add_u32 s56, s56, 8960
    v_lshlrev_b32 v7, 5, v3
    v_add_u32 v7, s56, v7
    v_mul_u32_u24 v8, 272, v2
    v_lshl_add_u32 v9, v3, 4, v8
    v_add_u32 v9, s70, v9
    v_mov_b32 v228, v202
    v_mov_b32 v229, v203
    v_mov_b32 v230, v204
    v_mov_b32 v231, v205
    s_mul_i32 s56, s91, 4352
    s_add_u32 s56, s56, 60928
    v_lshl_add_u32 v10, v3, 5, v8
    v_add_u32 v10, s56, v10
    v_add_u32 v11, 49152, v10
    s_lshl_b32 s56, s95, 6
    s_lshl_b32 s57, s91, 4
    s_add_u32 s56, s56, s57
    s_mul_i32 s56, s56, 896
    s_lshl_b32 s57, s96, 7
    s_add_u32 s56, s56, s57
    v_mul_u32_u24 v6, 896, v2
    v_lshl_add_u32 v6, v3, 4, v6
    v_add_u32 v6, s56, v6
    v_min_u32 v4, 6, v1
    s_mul_i32 s56, s95, 7
    v_add_u32 v4, s56, v4
    v_lshlrev_b32 v4, 6, v4
    v_add_u32 v4, 57344, v4
    s_cmp_lg_u32 s91, 0
    s_cbranch_scc1 L_w0_64
    s_mov_b32 s56, 0
L_poll_65:
    buffer_load_dwordx2 v[240:241], v4, s[52:55], 0 offen sc1
    s_waitcnt vmcnt(0)
L_pfirst_67:
    v_cmp_ne_u64 vcc, s[88:89], v[240:241]
    s_cmp_eq_u64 vcc, 0
    s_cbranch_scc1 L_pdone_66
    s_add_u32 s56, s56, 1
    s_cmp_lt_u32 s56, 131072
    s_cbranch_scc1 L_poll_65
L_pdone_66:
L_w0_64:
    s_barrier
    s_add_u32 s59, s7, s60
    s_add_u32 s59, s59, 0
    s_lshl_b32 s59, s59, 12
    buffer_load_dwordx4 v[128:131], v5, s[44:47], s59 offen offset:0 sc1
    buffer_load_dwordx4 v[132:135], v5, s[44:47], s59 offen offset:1024 sc1
    buffer_load_dwordx4 v[136:139], v5, s[44:47], s59 offen offset:2048 sc1
    buffer_load_dwordx4 v[140:143], v5, s[44:47], s59 offen offset:3072 sc1
    s_add_u32 s59, s7, s60
    s_add_u32 s59, s59, 1
    s_lshl_b32 s59, s59, 12
    buffer_load_dwordx4 v[144:147], v5, s[44:47], s59 offen offset:0 sc1
    buffer_load_dwordx4 v[148:151], v5, s[44:47], s59 offen offset:1024 sc1
    buffer_load_dwordx4 v[152:155], v5, s[44:47], s59 offen offset:2048 sc1
    buffer_load_dwordx4 v[156:159], v5, s[44:47], s59 offen offset:3072 sc1
    s_add_u32 s59, s8, s60
    s_add_u32 s59, s59, 0
    s_lshl_b32 s59, s59, 12
    buffer_load_dwordx4 v[160:163], v5, s[44:47], s59 offen offset:0 sc1
    buffer_load_dwordx4 v[164:167], v5, s[44:47], s59 offen offset:1024 sc1
    buffer_load_dwordx4 v[168:171], v5, s[44:47], s59 offen offset:2048 sc1
    buffer_load_dwordx4 v[172:175], v5, s[44:47], s59 offen offset:3072 sc1
    s_add_u32 s59, s8, s60
    s_add_u32 s59, s59, 1
    s_lshl_b32 s59, s59, 12
    buffer_load_dwordx4 v[176:179], v5, s[44:47], s59 offen offset:0 sc1
    buffer_load_dwordx4 v[180:183], v5, s[44:47], s59 offen offset:1024 sc1
    buffer_load_dwordx4 v[184:187], v5, s[44:47], s59 offen offset:2048 sc1
    buffer_load_dwordx4 v[188:191], v5, s[44:47], s59 offen offset:3072 sc1
    s_add_u32 s59, s9, s60
    s_add_u32 s59, s59, 0
    s_lshl_b32 s59, s59, 12
    buffer_load_dwordx4 v[192:195], v5, s[44:47], s59 offen offset:0 sc1
    buffer_load_dwordx4 v[196:199], v5, s[44:47], s59 offen offset:1024 sc1
    buffer_load_dwordx4 v[200:203], v5, s[44:47], s59 offen offset:2048 sc1
    buffer_load_dwordx4 v[204:207], v5, s[44:47], s59 offen offset:3072 sc1
    s_waitcnt vmcnt(16)
    v_mfma_f32_16x16x32_bf16 v[32:35], a[32:35], v[128:131], v[32:35]
    s_add_u32 s59, s9, s60
    s_add_u32 s59, s59, 1
    s_lshl_b32 s59, s59, 12
    buffer_load_dwordx4 v[208:211], v5, s[44:47], s59 offen offset:0 sc1
    v_mfma_f32_16x16x32_bf16 v[36:39], a[32:35], v[132:135], v[36:39]
    ds_read_b64_tr_b16 a[80:81], v12 offset:0
    v_mfma_f32_16x16x32_bf16 v[40:43], a[32:35], v[136:139], v[40:43]
    ds_read_b64_tr_b16 a[82:83], v12 offset:2048
    v_mfma_f32_16x16x32_bf16 v[44:47], a[32:35], v[140:143], v[44:47]
    ds_read_b64_tr_b16 a[84:85], v13 offset:0
    v_mfma_f32_16x16x32_bf16 v[48:51], a[36:39], v[128:131], v[48:51]
    buffer_load_dwordx4 v[212:215], v5, s[44:47], s59 offen offset:1024 sc1
    v_mfma_f32_16x16x32_bf16 v[52:55], a[36:39], v[132:135], v[52:55]
    ds_read_b64_tr_b16 a[86:87], v13 offset:2048
    v_mfma_f32_16x16x32_bf16 v[56:59], a[36:39], v[136:139], v[56:59]
    ds_read_b64_tr_b16 a[88:89], v14 offset:0
    v_mfma_f32_16x16x32_bf16 v[60:63], a[36:39], v[140:143], v[60:63]
    ds_read_b64_tr_b16 a[90:91], v14 offset:2048
    v_mfma_f32_16x16x32_bf16 v[64:67], a[40:43], v[128:131], v[64:67]
    buffer_load_dwordx4 v[216:219], v5, s[44:47], s59 offen offset:2048 sc1
    v_mfma_f32_16x16x32_bf16 v[68:71], a[40:43], v[132:135], v[68:71]
    ds_read_b64_tr_b16 a[92:93], v15 offset:0
    v_mfma_f32_16x16x32_bf16 v[72:75], a[40:43], v[136:139], v[72:75]
    ds_read_b64_tr_b16 a[94:95], v15 offset:2048
    v_mfma_f32_16x16x32_bf16 v[76:79], a[40:43], v[140:143], v[76:79]
    v_mfma_f32_16x16x32_bf16 v[80:83], a[44:47], v[128:131], v[80:83]
    buffer_load_dwordx4 v[220:223], v5, s[44:47], s59 offen offset:3072 sc1
    v_mfma_f32_16x16x32_bf16 v[84:87], a[44:47], v[132:135], v[84:87]
    v_mfma_f32_16x16x32_bf16 v[88:91], a[44:47], v[136:139], v[88:91]
    v_mfma_f32_16x16x32_bf16 v[92:95], a[44:47], v[140:143], v[92:95]
    s_waitcnt vmcnt(16)
    s_waitcnt lgkmcnt(0)
    v_mfma_f32_16x16x32_bf16 v[32:35], a[48:51], v[144:147], v[32:35]
    s_add_u32 s59, s10, s60
    s_add_u32 s59, s59, 0
    s_lshl_b32 s59, s59, 12
    buffer_load_dwordx4 v[96:99], v5, s[44:47], s59 offen offset:0 sc1
    v_mfma_f32_16x16x32_bf16 v[36:39], a[48:51], v[148:151], v[36:39]
    ds_read_b64_tr_b16 a[96:97], v12 offset:4096
    s_add_u32 m0, s63, 0
    s_add_u32 s71, s12, 1
    s_mul_i32 s71, s71, 28672
    buffer_load_dwordx4 v228, s[36:39], s71 offen offset:0 lds
    v_mfma_f32_16x16x32_bf16 v[40:43], a[48:51], v[152:155], v[40:43]
    ds_read_b64_tr_b16 a[98:99], v12 offset:6144
    v_mfma_f32_16x16x32_bf16 v[44:47], a[48:51], v[156:159], v[44:47]
    ds_read_b64_tr_b16 a[100:101], v13 offset:4096
    buffer_load_dwordx4 v229, s[36:39], s71 offen offset:1024 lds
    v_mfma_f32_16x16x32_bf16 v[48:51], a[52:55], v[144:147], v[48:51]
    buffer_load_dwordx4 v[100:103], v5, s[44:47], s59 offen offset:1024 sc1
    v_mfma_f32_16x16x32_bf16 v[52:55], a[52:55], v[148:151], v[52:55]
    ds_read_b64_tr_b16 a[102:103], v13 offset:6144
    buffer_load_dwordx4 v230, s[36:39], s71 offen offset:2048 lds
    v_mfma_f32_16x16x32_bf16 v[56:59], a[52:55], v[152:155], v[56:59]
    ds_read_b64_tr_b16 a[104:105], v14 offset:4096
    v_mfma_f32_16x16x32_bf16 v[60:63], a[52:55], v[156:159], v[60:63]
    ds_read_b64_tr_b16 a[106:107], v14 offset:6144
    buffer_load_dwordx4 v231, s[36:39], s71 offen offset:3072 lds
    v_mfma_f32_16x16x32_bf16 v[64:67], a[56:59], v[144:147], v[64:67]
    buffer_load_dwordx4 v[104:107], v5, s[44:47], s59 offen offset:2048 sc1
    v_mfma_f32_16x16x32_bf16 v[68:71], a[56:59], v[148:151], v[68:71]
    ds_read_b64_tr_b16 a[108:109], v15 offset:4096
    v_mfma_f32_16x16x32_bf16 v[72:75], a[56:59], v[152:155], v[72:75]
    ds_read_b64_tr_b16 a[110:111], v15 offset:6144
    v_mfma_f32_16x16x32_bf16 v[76:79], a[56:59], v[156:159], v[76:79]
    v_mfma_f32_16x16x32_bf16 v[80:83], a[60:63], v[144:147], v[80:83]
    buffer_load_dwordx4 v[108:111], v5, s[44:47], s59 offen offset:3072 sc1
    v_mfma_f32_16x16x32_bf16 v[84:87], a[60:63], v[148:151], v[84:87]
    v_mfma_f32_16x16x32_bf16 v[88:91], a[60:63], v[152:155], v[88:91]
    v_mfma_f32_16x16x32_bf16 v[92:95], a[60:63], v[156:159], v[92:95]
    s_waitcnt vmcnt(20)
    v_mfma_f32_16x16x32_bf16 v[32:35], a[64:67], v[160:163], v[32:35]
    s_add_u32 s59, s10, s60
    s_add_u32 s59, s59, 1
    s_lshl_b32 s59, s59, 12
    buffer_load_dwordx4 v[112:115], v5, s[44:47], s59 offen offset:0 sc1
    v_mfma_f32_16x16x32_bf16 v[36:39], a[64:67], v[164:167], v[36:39]
    ds_read_b64_tr_b16 a[112:113], v12 offset:8192
    v_mfma_f32_16x16x32_bf16 v[40:43], a[64:67], v[168:171], v[40:43]
    ds_read_b64_tr_b16 a[114:115], v12 offset:10240
    v_mfma_f32_16x16x32_bf16 v[44:47], a[64:67], v[172:175], v[44:47]
    ds_read_b64_tr_b16 a[116:117], v13 offset:8192
    v_mfma_f32_16x16x32_bf16 v[48:51], a[68:71], v[160:163], v[48:51]
    buffer_load_dwordx4 v[116:119], v5, s[44:47], s59 offen offset:1024 sc1
    v_mfma_f32_16x16x32_bf16 v[52:55], a[68:71], v[164:167], v[52:55]
    ds_read_b64_tr_b16 a[118:119], v13 offset:10240
    v_mfma_f32_16x16x32_bf16 v[56:59], a[68:71], v[168:171], v[56:59]
    ds_read_b64_tr_b16 a[120:121], v14 offset:8192
    v_mfma_f32_16x16x32_bf16 v[60:63], a[68:71], v[172:175], v[60:63]
    ds_read_b64_tr_b16 a[122:123], v14 offset:10240
    v_mfma_f32_16x16x32_bf16 v[64:67], a[72:75], v[160:163], v[64:67]
    buffer_load_dwordx4 v[120:123], v5, s[44:47], s59 offen offset:2048 sc1
    v_mfma_f32_16x16x32_bf16 v[68:71], a[72:75], v[164:167], v[68:71]
    ds_read_b64_tr_b16 a[124:125], v15 offset:8192
    v_mfma_f32_16x16x32_bf16 v[72:75], a[72:75], v[168:171], v[72:75]
    ds_read_b64_tr_b16 a[126:127], v15 offset:10240
    v_mfma_f32_16x16x32_bf16 v[76:79], a[72:75], v[172:175], v[76:79]
    v_mfma_f32_16x16x32_bf16 v[80:83], a[76:79], v[160:163], v[80:83]
    buffer_load_dwordx4 v[124:127], v5, s[44:47], s59 offen offset:3072 sc1
    v_mfma_f32_16x16x32_bf16 v[84:87], a[76:79], v[164:167], v[84:87]
    v_mfma_f32_16x16x32_bf16 v[88:91], a[76:79], v[168:171], v[88:91]
    v_mfma_f32_16x16x32_bf16 v[92:95], a[76:79], v[172:175], v[92:95]
    s_waitcnt vmcnt(20)
    s_waitcnt lgkmcnt(15)
    v_mfma_f32_16x16x32_bf16 v[32:35], a[80:83], v[176:179], v[32:35]
    s_add_u32 s59, s11, s60
    s_add_u32 s59, s59, 0
    s_lshl_b32 s59, s59, 12
    buffer_load_dwordx4 v[128:131], v5, s[44:47], s59 offen offset:0 sc1
    v_mfma_f32_16x16x32_bf16 v[36:39], a[80:83], v[180:183], v[36:39]
    ds_read_b64_tr_b16 a[128:129], v224 offset:14336
    v_mfma_f32_16x16x32_bf16 v[40:43], a[80:83], v[184:187], v[40:43]
    ds_read_b64_tr_b16 a[130:131], v224 offset:16384
    v_mfma_f32_16x16x32_bf16 v[44:47], a[80:83], v[188:191], v[44:47]
    ds_read_b64_tr_b16 a[132:133], v225 offset:14336
    v_mfma_f32_16x16x32_bf16 v[48:51], a[84:87], v[176:179], v[48:51]
    buffer_load_dwordx4 v[132:135], v5, s[44:47], s59 offen offset:1024 sc1
    v_mfma_f32_16x16x32_bf16 v[52:55], a[84:87], v[180:183], v[52:55]
    ds_read_b64_tr_b16 a[134:135], v225 offset:16384
    v_mfma_f32_16x16x32_bf16 v[56:59], a[84:87], v[184:187], v[56:59]
    ds_read_b64_tr_b16 a[136:137], v226 offset:14336
    v_mfma_f32_16x16x32_bf16 v[60:63], a[84:87], v[188:191], v[60:63]
    ds_read_b64_tr_b16 a[138:139], v226 offset:16384
    v_mfma_f32_16x16x32_bf16 v[64:67], a[88:91], v[176:179], v[64:67]
    buffer_load_dwordx4 v[136:139], v5, s[44:47], s59 offen offset:2048 sc1
    v_mfma_f32_16x16x32_bf16 v[68:71], a[88:91], v[180:183], v[68:71]
    ds_read_b64_tr_b16 a[140:141], v227 offset:14336
    v_mfma_f32_16x16x32_bf16 v[72:75], a[88:91], v[184:187], v[72:75]
    ds_read_b64_tr_b16 a[142:143], v227 offset:16384
    v_mfma_f32_16x16x32_bf16 v[76:79], a[88:91], v[188:191], v[76:79]
    v_mfma_f32_16x16x32_bf16 v[80:83], a[92:95], v[176:179], v[80:83]
    buffer_load_dwordx4 v[140:143], v5, s[44:47], s59 offen offset:3072 sc1
    v_mfma_f32_16x16x32_bf16 v[84:87], a[92:95], v[180:183], v[84:87]
    v_mfma_f32_16x16x32_bf16 v[88:91], a[92:95], v[184:187], v[88:91]
    v_mfma_f32_16x16x32_bf16 v[92:95], a[92:95], v[188:191], v[92:95]
    s_waitcnt vmcnt(20)
    s_waitcnt lgkmcnt(15)
    v_mfma_f32_16x16x32_bf16 v[32:35], a[96:99], v[192:195], v[32:35]
    s_add_u32 s59, s11, s60
    s_add_u32 s59, s59, 1
    s_lshl_b32 s59, s59, 12
    buffer_load_dwordx4 v[144:147], v5, s[44:47], s59 offen offset:0 sc1
    v_mfma_f32_16x16x32_bf16 v[36:39], a[96:99], v[196:199], v[36:39]
    ds_read_b64_tr_b16 a[144:145], v224 offset:0
    v_mfma_f32_16x16x32_bf16 v[40:43], a[96:99], v[200:203], v[40:43]
    ds_read_b64_tr_b16 a[146:147], v224 offset:2048
    v_mfma_f32_16x16x32_bf16 v[44:47], a[96:99], v[204:207], v[44:47]
    ds_read_b64_tr_b16 a[148:149], v225 offset:0
    v_mfma_f32_16x16x32_bf16 v[48:51], a[100:103], v[192:195], v[48:51]
    buffer_load_dwordx4 v[148:151], v5, s[44:47], s59 offen offset:1024 sc1
    v_mfma_f32_16x16x32_bf16 v[52:55], a[100:103], v[196:199], v[52:55]
    ds_read_b64_tr_b16 a[150:151], v225 offset:2048
    v_mfma_f32_16x16x32_bf16 v[56:59], a[100:103], v[200:203], v[56:59]
    ds_read_b64_tr_b16 a[152:153], v226 offset:0
    v_mfma_f32_16x16x32_bf16 v[60:63], a[100:103], v[204:207], v[60:63]
    ds_read_b64_tr_b16 a[154:155], v226 offset:2048
    v_mfma_f32_16x16x32_bf16 v[64:67], a[104:107], v[192:195], v[64:67]
    buffer_load_dwordx4 v[152:155], v5, s[44:47], s59 offen offset:2048 sc1
    v_mfma_f32_16x16x32_bf16 v[68:71], a[104:107], v[196:199], v[68:71]
    ds_read_b64_tr_b16 a[156:157], v227 offset:0
    v_mfma_f32_16x16x32_bf16 v[72:75], a[104:107], v[200:203], v[72:75]
    ds_read_b64_tr_b16 a[158:159], v227 offset:2048
    v_mfma_f32_16x16x32_bf16 v[76:79], a[104:107], v[204:207], v[76:79]
    v_mfma_f32_16x16x32_bf16 v[80:83], a[108:111], v[192:195], v[80:83]
    buffer_load_dwordx4 v[156:159], v5, s[44:47], s59 offen offset:3072 sc1
    v_mfma_f32_16x16x32_bf16 v[84:87], a[108:111], v[196:199], v[84:87]
    v_mfma_f32_16x16x32_bf16 v[88:91], a[108:111], v[200:203], v[88:91]
    v_mfma_f32_16x16x32_bf16 v[92:95], a[108:111], v[204:207], v[92:95]
    s_waitcnt vmcnt(20)
    s_waitcnt lgkmcnt(15)
    v_mfma_f32_16x16x32_bf16 v[32:35], a[112:115], v[208:211], v[32:35]
    s_add_u32 s59, s12, s60
    s_add_u32 s59, s59, 0
    s_lshl_b32 s59, s59, 12
    buffer_load_dwordx4 v[160:163], v5, s[44:47], s59 offen offset:0 sc1
    v_mfma_f32_16x16x32_bf16 v[36:39], a[112:115], v[212:215], v[36:39]
    ds_read_b64_tr_b16 a[160:161], v224 offset:4096
    v_mfma_f32_16x16x32_bf16 v[40:43], a[112:115], v[216:219], v[40:43]
    ds_read_b64_tr_b16 a[162:163], v224 offset:6144
    v_mfma_f32_16x16x32_bf16 v[44:47], a[112:115], v[220:223], v[44:47]
    ds_read_b64_tr_b16 a[164:165], v225 offset:4096
    v_mfma_f32_16x16x32_bf16 v[48:51], a[116:119], v[208:211], v[48:51]
    buffer_load_dwordx4 v[164:167], v5, s[44:47], s59 offen offset:1024 sc1
    v_mfma_f32_16x16x32_bf16 v[52:55], a[116:119], v[212:215], v[52:55]
    ds_read_b64_tr_b16 a[166:167], v225 offset:6144
    v_mfma_f32_16x16x32_bf16 v[56:59], a[116:119], v[216:219], v[56:59]
    ds_read_b64_tr_b16 a[168:169], v226 offset:4096
    v_mfma_f32_16x16x32_bf16 v[60:63], a[116:119], v[220:223], v[60:63]
    ds_read_b64_tr_b16 a[170:171], v226 offset:6144
    v_mfma_f32_16x16x32_bf16 v[64:67], a[120:123], v[208:211], v[64:67]
    buffer_load_dwordx4 v[168:171], v5, s[44:47], s59 offen offset:2048 sc1
    v_mfma_f32_16x16x32_bf16 v[68:71], a[120:123], v[212:215], v[68:71]
    ds_read_b64_tr_b16 a[172:173], v227 offset:4096
    v_mfma_f32_16x16x32_bf16 v[72:75], a[120:123], v[216:219], v[72:75]
    ds_read_b64_tr_b16 a[174:175], v227 offset:6144
    v_mfma_f32_16x16x32_bf16 v[76:79], a[120:123], v[220:223], v[76:79]
    v_mfma_f32_16x16x32_bf16 v[80:83], a[124:127], v[208:211], v[80:83]
    buffer_load_dwordx4 v[172:175], v5, s[44:47], s59 offen offset:3072 sc1
    v_mfma_f32_16x16x32_bf16 v[84:87], a[124:127], v[212:215], v[84:87]
    v_mfma_f32_16x16x32_bf16 v[88:91], a[124:127], v[216:219], v[88:91]
    v_mfma_f32_16x16x32_bf16 v[92:95], a[124:127], v[220:223], v[92:95]
    s_waitcnt vmcnt(16)
    s_waitcnt lgkmcnt(15)
    v_mfma_f32_16x16x32_bf16 v[32:35], a[128:131], v[96:99], v[32:35]
    s_add_u32 s59, s12, s60
    s_add_u32 s59, s59, 1
    s_lshl_b32 s59, s59, 12
    buffer_load_dwordx4 v[176:179], v5, s[44:47], s59 offen offset:0 sc1
    v_mfma_f32_16x16x32_bf16 v[36:39], a[128:131], v[100:103], v[36:39]
    ds_read_b64_tr_b16 a[176:177], v224 offset:8192
    v_mfma_f32_16x16x32_bf16 v[40:43], a[128:131], v[104:107], v[40:43]
    ds_read_b64_tr_b16 a[178:179], v224 offset:10240
    v_mfma_f32_16x16x32_bf16 v[44:47], a[128:131], v[108:111], v[44:47]
    ds_read_b64_tr_b16 a[180:181], v225 offset:8192
    v_mfma_f32_16x16x32_bf16 v[48:51], a[132:135], v[96:99], v[48:51]
    buffer_load_dwordx4 v[180:183], v5, s[44:47], s59 offen offset:1024 sc1
    v_mfma_f32_16x16x32_bf16 v[52:55], a[132:135], v[100:103], v[52:55]
    ds_read_b64_tr_b16 a[182:183], v225 offset:10240
    v_mfma_f32_16x16x32_bf16 v[56:59], a[132:135], v[104:107], v[56:59]
    ds_read_b64_tr_b16 a[184:185], v226 offset:8192
    v_mfma_f32_16x16x32_bf16 v[60:63], a[132:135], v[108:111], v[60:63]
    ds_read_b64_tr_b16 a[186:187], v226 offset:10240
    v_mfma_f32_16x16x32_bf16 v[64:67], a[136:139], v[96:99], v[64:67]
    buffer_load_dwordx4 v[184:187], v5, s[44:47], s59 offen offset:2048 sc1
    v_mfma_f32_16x16x32_bf16 v[68:71], a[136:139], v[100:103], v[68:71]
    ds_read_b64_tr_b16 a[188:189], v227 offset:8192
    v_mfma_f32_16x16x32_bf16 v[72:75], a[136:139], v[104:107], v[72:75]
    ds_read_b64_tr_b16 a[190:191], v227 offset:10240
    v_mfma_f32_16x16x32_bf16 v[76:79], a[136:139], v[108:111], v[76:79]
    v_mfma_f32_16x16x32_bf16 v[80:83], a[140:143], v[96:99], v[80:83]
    buffer_load_dwordx4 v[188:191], v5, s[44:47], s59 offen offset:3072 sc1
    v_mfma_f32_16x16x32_bf16 v[84:87], a[140:143], v[100:103], v[84:87]
    v_mfma_f32_16x16x32_bf16 v[88:91], a[140:143], v[104:107], v[88:91]
    v_mfma_f32_16x16x32_bf16 v[92:95], a[140:143], v[108:111], v[92:95]
    s_waitcnt vmcnt(16)
    s_waitcnt lgkmcnt(15)
    v_mfma_f32_16x16x32_bf16 v[32:35], a[144:147], v[112:115], v[32:35]
    ds_read_b64_tr_b16 a[192:193], v224 offset:18432
    v_mfma_f32_16x16x32_bf16 v[36:39], a[144:147], v[116:119], v[36:39]
    ds_read_b64_tr_b16 a[194:195], v224 offset:20480
    v_mfma_f32_16x16x32_bf16 v[40:43], a[144:147], v[120:123], v[40:43]
    ds_read_b64_tr_b16 a[196:197], v225 offset:18432
    v_mfma_f32_16x16x32_bf16 v[44:47], a[144:147], v[124:127], v[44:47]
    ds_read_b64_tr_b16 a[198:199], v225 offset:20480
    v_mfma_f32_16x16x32_bf16 v[48:51], a[148:151], v[112:115], v[48:51]
    ds_read_b64_tr_b16 a[200:201], v226 offset:18432
    v_mfma_f32_16x16x32_bf16 v[52:55], a[148:151], v[116:119], v[52:55]
    ds_read_b64_tr_b16 a[202:203], v226 offset:20480
    v_mfma_f32_16x16x32_bf16 v[56:59], a[148:151], v[120:123], v[56:59]
    ds_read_b64_tr_b16 a[204:205], v227 offset:18432
    v_mfma_f32_16x16x32_bf16 v[60:63], a[148:151], v[124:127], v[60:63]
    ds_read_b64_tr_b16 a[206:207], v227 offset:20480
    v_mfma_f32_16x16x32_bf16 v[64:67], a[152:155], v[112:115], v[64:67]
    v_mfma_f32_16x16x32_bf16 v[68:71], a[152:155], v[116:119], v[68:71]
    v_mfma_f32_16x16x32_bf16 v[72:75], a[152:155], v[120:123], v[72:75]
    v_mfma_f32_16x16x32_bf16 v[76:79], a[152:155], v[124:127], v[76:79]
    v_mfma_f32_16x16x32_bf16 v[80:83], a[156:159], v[112:115], v[80:83]
    v_mfma_f32_16x16x32_bf16 v[84:87], a[156:159], v[116:119], v[84:87]
    v_mfma_f32_16x16x32_bf16 v[88:91], a[156:159], v[120:123], v[88:91]
    v_mfma_f32_16x16x32_bf16 v[92:95], a[156:159], v[124:127], v[92:95]
    s_waitcnt vmcnt(12)
    s_waitcnt lgkmcnt(15)
    v_mfma_f32_16x16x32_bf16 v[32:35], a[160:163], v[128:131], v[32:35]
    ds_read_b64_tr_b16 a[208:209], v12 offset:0
    v_mfma_f32_16x16x32_bf16 v[36:39], a[160:163], v[132:135], v[36:39]
    ds_read_b64_tr_b16 a[210:211], v12 offset:2048
    v_mfma_f32_16x16x32_bf16 v[40:43], a[160:163], v[136:139], v[40:43]
    ds_read_b64_tr_b16 a[212:213], v13 offset:0
    v_mfma_f32_16x16x32_bf16 v[44:47], a[160:163], v[140:143], v[44:47]
    ds_read_b64_tr_b16 a[214:215], v13 offset:2048
    v_mfma_f32_16x16x32_bf16 v[48:51], a[164:167], v[128:131], v[48:51]
    ds_read_b64_tr_b16 a[216:217], v14 offset:0
    v_mfma_f32_16x16x32_bf16 v[52:55], a[164:167], v[132:135], v[52:55]
    ds_read_b64_tr_b16 a[218:219], v14 offset:2048
    v_mfma_f32_16x16x32_bf16 v[56:59], a[164:167], v[136:139], v[56:59]
    ds_read_b64_tr_b16 a[220:221], v15 offset:0
    v_mfma_f32_16x16x32_bf16 v[60:63], a[164:167], v[140:143], v[60:63]
    ds_read_b64_tr_b16 a[222:223], v15 offset:2048
    v_mfma_f32_16x16x32_bf16 v[64:67], a[168:171], v[128:131], v[64:67]
    v_mfma_f32_16x16x32_bf16 v[68:71], a[168:171], v[132:135], v[68:71]
    v_mfma_f32_16x16x32_bf16 v[72:75], a[168:171], v[136:139], v[72:75]
    v_mfma_f32_16x16x32_bf16 v[76:79], a[168:171], v[140:143], v[76:79]
    v_mfma_f32_16x16x32_bf16 v[80:83], a[172:175], v[128:131], v[80:83]
    v_mfma_f32_16x16x32_bf16 v[84:87], a[172:175], v[132:135], v[84:87]
    v_mfma_f32_16x16x32_bf16 v[88:91], a[172:175], v[136:139], v[88:91]
    v_mfma_f32_16x16x32_bf16 v[92:95], a[172:175], v[140:143], v[92:95]
    s_waitcnt vmcnt(8)
    s_waitcnt lgkmcnt(15)
    v_mfma_f32_16x16x32_bf16 v[32:35], a[176:179], v[144:147], v[32:35]
    v_mfma_f32_16x16x32_bf16 v[36:39], a[176:179], v[148:151], v[36:39]
    buffer_load_dwordx4 v[240:243], v7, s[40:43], 0 offen offset:0 sc1
    v_mfma_f32_16x16x32_bf16 v[40:43], a[176:179], v[152:155], v[40:43]
    v_mfma_f32_16x16x32_bf16 v[44:47], a[176:179], v[156:159], v[44:47]
    v_mfma_f32_16x16x32_bf16 v[48:51], a[180:183], v[144:147], v[48:51]
    v_mfma_f32_16x16x32_bf16 v[52:55], a[180:183], v[148:151], v[52:55]
    buffer_load_dwordx4 v[244:247], v7, s[40:43], 0 offen offset:16 sc1
    v_mfma_f32_16x16x32_bf16 v[56:59], a[180:183], v[152:155], v[56:59]
    v_mfma_f32_16x16x32_bf16 v[60:63], a[180:183], v[156:159], v[60:63]
    v_mfma_f32_16x16x32_bf16 v[64:67], a[184:187], v[144:147], v[64:67]
    v_mfma_f32_16x16x32_bf16 v[68:71], a[184:187], v[148:151], v[68:71]
    buffer_load_dwordx4 v[248:251], v7, s[40:43], 0 offen offset:128 sc1
    v_mfma_f32_16x16x32_bf16 v[72:75], a[184:187], v[152:155], v[72:75]
    v_mfma_f32_16x16x32_bf16 v[76:79], a[184:187], v[156:159], v[76:79]
    v_mfma_f32_16x16x32_bf16 v[80:83], a[188:191], v[144:147], v[80:83]
    v_mfma_f32_16x16x32_bf16 v[84:87], a[188:191], v[148:151], v[84:87]
    buffer_load_dwordx4 v[252:255], v7, s[40:43], 0 offen offset:144 sc1
    v_mfma_f32_16x16x32_bf16 v[88:91], a[188:191], v[152:155], v[88:91]
    v_mfma_f32_16x16x32_bf16 v[92:95], a[188:191], v[156:159], v[92:95]
    s_waitcnt vmcnt(4)
    s_waitcnt lgkmcnt(0)
    v_mfma_f32_16x16x32_bf16 v[32:35], a[192:195], v[160:163], v[32:35]
    v_mfma_f32_16x16x32_bf16 v[32:35], a[208:211], v[176:179], v[32:35]
    v_mfma_f32_16x16x32_bf16 v[36:39], a[192:195], v[164:167], v[36:39]
    v_mfma_f32_16x16x32_bf16 v[36:39], a[208:211], v[180:183], v[36:39]
    v_mfma_f32_16x16x32_bf16 v[40:43], a[192:195], v[168:171], v[40:43]
    v_mfma_f32_16x16x32_bf16 v[40:43], a[208:211], v[184:187], v[40:43]
    v_mfma_f32_16x16x32_bf16 v[44:47], a[192:195], v[172:175], v[44:47]
    v_mfma_f32_16x16x32_bf16 v[44:47], a[208:211], v[188:191], v[44:47]
    v_mfma_f32_16x16x32_bf16 v[48:51], a[196:199], v[160:163], v[48:51]
    v_mfma_f32_16x16x32_bf16 v[48:51], a[212:215], v[176:179], v[48:51]
    v_mfma_f32_16x16x32_bf16 v[52:55], a[196:199], v[164:167], v[52:55]
    ds_write_b128 v9, v[32:35] offset:0
    v_mfma_f32_16x16x32_bf16 v[52:55], a[212:215], v[180:183], v[52:55]
    v_mfma_f32_16x16x32_bf16 v[56:59], a[196:199], v[168:171], v[56:59]
    ds_write_b128 v9, v[36:39] offset:4352
    v_mfma_f32_16x16x32_bf16 v[56:59], a[212:215], v[184:187], v[56:59]
    v_mfma_f32_16x16x32_bf16 v[60:63], a[196:199], v[172:175], v[60:63]
    ds_write_b128 v9, v[40:43] offset:8704
    v_mfma_f32_16x16x32_bf16 v[60:63], a[212:215], v[188:191], v[60:63]
    v_mfma_f32_16x16x32_bf16 v[64:67], a[200:203], v[160:163], v[64:67]
    ds_write_b128 v9, v[44:47] offset:13056
    v_mfma_f32_16x16x32_bf16 v[64:67], a[216:219], v[176:179], v[64:67]
    v_mfma_f32_16x16x32_bf16 v[68:71], a[200:203], v[164:167], v[68:71]
    ds_write_b128 v9, v[48:51] offset:64
    v_mfma_f32_16x16x32_bf16 v[68:71], a[216:219], v[180:183], v[68:71]
    v_mfma_f32_16x16x32_bf16 v[72:75], a[200:203], v[168:171], v[72:75]
    ds_write_b128 v9, v[52:55] offset:4416
    v_mfma_f32_16x16x32_bf16 v[72:75], a[216:219], v[184:187], v[72:75]
    v_mfma_f32_16x16x32_bf16 v[76:79], a[200:203], v[172:175], v[76:79]
    ds_write_b128 v9, v[56:59] offset:8768
    v_mfma_f32_16x16x32_bf16 v[76:79], a[216:219], v[188:191], v[76:79]
    v_mfma_f32_16x16x32_bf16 v[80:83], a[204:207], v[160:163], v[80:83]
    ds_write_b128 v9, v[60:63] offset:13120
    v_mfma_f32_16x16x32_bf16 v[80:83], a[220:223], v[176:179], v[80:83]
    v_mfma_f32_16x16x32_bf16 v[84:87], a[204:207], v[164:167], v[84:87]
    ds_write_b128 v9, v[64:67] offset:128
    v_mfma_f32_16x16x32_bf16 v[84:87], a[220:223], v[180:183], v[84:87]
    v_mfma_f32_16x16x32_bf16 v[88:91], a[204:207], v[168:171], v[88:91]
    ds_write_b128 v9, v[68:71] offset:4480
    v_mfma_f32_16x16x32_bf16 v[88:91], a[220:223], v[184:187], v[88:91]
    v_mfma_f32_16x16x32_bf16 v[92:95], a[204:207], v[172:175], v[92:95]
    ds_write_b128 v9, v[72:75] offset:8832
    v_mfma_f32_16x16x32_bf16 v[92:95], a[220:223], v[188:191], v[92:95]
    ds_write_b128 v9, v[76:79] offset:13184
    ds_write_b128 v9, v[80:83] offset:192
    ds_write_b128 v9, v[84:87] offset:4544
    s_nop 1
    ds_write_b128 v9, v[88:91] offset:8896
    s_nop 3
    ds_write_b128 v9, v[92:95] offset:13248
    s_waitcnt lgkmcnt(0)
    s_barrier
    ds_read_b128 v[96:99], v10 offset:0
    ds_read_b128 v[100:103], v10 offset:16
    ds_read_b128 v[104:107], v10 offset:24576
    ds_read_b128 v[108:111], v10 offset:24592
    ds_read_b128 v[112:115], v11 offset:0
    ds_read_b128 v[116:119], v11 offset:16
    ds_read_b128 v[120:123], v11 offset:24576
    ds_read_b128 v[124:127], v11 offset:24592
    ds_read_b128 v[128:131], v10 offset:128
    ds_read_b128 v[132:135], v10 offset:144
    ds_read_b128 v[136:139], v10 offset:24704
    ds_read_b128 v[140:143], v10 offset:24720
    ds_read_b128 v[144:147], v11 offset:128
    ds_read_b128 v[148:151], v11 offset:144
    ds_read_b128 v[152:155], v11 offset:24704
    ds_read_b128 v[156:159], v11 offset:24720
    s_waitcnt vmcnt(0)
    s_waitcnt lgkmcnt(8)
    v_pk_add_f32 v[96:97], v[96:97], v[104:105]
    v_pk_add_f32 v[112:113], v[112:113], v[120:121]
    v_pk_add_f32 v[98:99], v[98:99], v[106:107]
    v_pk_add_f32 v[114:115], v[114:115], v[122:123]
    v_pk_add_f32 v[100:101], v[100:101], v[108:109]
    v_pk_add_f32 v[116:117], v[116:117], v[124:125]
    v_pk_add_f32 v[102:103], v[102:103], v[110:111]
    v_pk_add_f32 v[118:119], v[118:119], v[126:127]
    v_pk_add_f32 v[96:97], v[96:97], v[112:113]
    v_lshlrev_b32 v160, 16, v232
    v_and_b32 v161, s90, v232
    v_pk_add_f32 v[98:99], v[98:99], v[114:115]
    v_lshlrev_b32 v162, 16, v233
    v_and_b32 v163, s90, v233
    v_pk_add_f32 v[100:101], v[100:101], v[116:117]
    v_lshlrev_b32 v164, 16, v234
    v_and_b32 v165, s90, v234
    v_pk_add_f32 v[102:103], v[102:103], v[118:119]
    v_lshlrev_b32 v166, 16, v235
    v_and_b32 v167, s90, v235
    v_pk_fma_f32 v[96:97], v[96:97], v[240:241], v[160:161]
    v_pk_fma_f32 v[98:99], v[98:99], v[242:243], v[162:163]
    v_pk_fma_f32 v[100:101], v[100:101], v[244:245], v[164:165]
    v_pk_fma_f32 v[102:103], v[102:103], v[246:247], v[166:167]
    v_cvt_pk_bf16_f32 v168, v96, v97
    v_cvt_pk_bf16_f32 v169, v98, v99
    v_cvt_pk_bf16_f32 v170, v100, v101
    v_cvt_pk_bf16_f32 v171, v102, v103
    buffer_store_dwordx4 v[168:171], v6, s[32:35], 0 offen offset:0 nt
    s_waitcnt lgkmcnt(0)
    v_pk_add_f32 v[128:129], v[128:129], v[136:137]
    v_pk_add_f32 v[144:145], v[144:145], v[152:153]
    v_pk_add_f32 v[130:131], v[130:131], v[138:139]
    v_pk_add_f32 v[146:147], v[146:147], v[154:155]
    v_pk_add_f32 v[132:133], v[132:133], v[140:141]
    v_pk_add_f32 v[148:149], v[148:149], v[156:157]
    v_pk_add_f32 v[134:135], v[134:135], v[142:143]
    v_pk_add_f32 v[150:151], v[150:151], v[158:159]
    v_pk_add_f32 v[128:129], v[128:129], v[144:145]
    v_lshlrev_b32 v160, 16, v236
    v_and_b32 v161, s90, v236
    v_pk_add_f32 v[130:131], v[130:131], v[146:147]
    v_lshlrev_b32 v162, 16, v237
    v_and_b32 v163, s90, v237
    v_pk_add_f32 v[132:133], v[132:133], v[148:149]
    v_lshlrev_b32 v164, 16, v238
    v_and_b32 v165, s90, v238
    v_pk_add_f32 v[134:135], v[134:135], v[150:151]
    v_lshlrev_b32 v166, 16, v239
    v_and_b32 v167, s90, v239
    v_pk_fma_f32 v[128:129], v[128:129], v[248:249], v[160:161]
    v_pk_fma_f32 v[130:131], v[130:131], v[250:251], v[162:163]
    v_pk_fma_f32 v[132:133], v[132:133], v[252:253], v[164:165]
    v_pk_fma_f32 v[134:135], v[134:135], v[254:255], v[166:167]
    v_cvt_pk_bf16_f32 v172, v128, v129
    v_cvt_pk_bf16_f32 v173, v130, v131
    v_cvt_pk_bf16_f32 v174, v132, v133
    v_cvt_pk_bf16_f32 v175, v134, v135
    buffer_store_dwordx4 v[172:175], v6, s[32:35], 0 offen offset:64 nt
L_fin:
L_end:
    s_endpgm
L_code_end:
.section .rodata,"a"
.p2align 6
.amdhsa_kernel adaLN_cond__ssm_conv_h3__dense_activation_silu__prompt_kernel
  .amdhsa_next_free_vgpr 512
  .amdhsa_next_free_sgpr 100
  .amdhsa_accum_offset 256
  .amdhsa_group_segment_fixed_size 0
  .amdhsa_kernarg_size 112
  .amdhsa_user_sgpr_count 2
  .amdhsa_user_sgpr_kernarg_segment_ptr 1
  .amdhsa_system_sgpr_workgroup_id_x 1
.end_amdhsa_kernel
```
